```python
import torch

def _softmax(x, axis=-1):
    return torch.softmax(x, dim=axis)
def _gelu(x):
    return torch.nn.functional.gelu(x, approximate="tanh")
def _silu(x):
    return torch.nn.functional.silu(x)
def _sigmoid(x):
    return torch.sigmoid(x)
def _layernorm(x, axis=-1, eps=1e-5):
    m = x.mean(dim=axis, keepdim=True)
    v = x.var(dim=axis, keepdim=True, unbiased=False)
    return (x - m) / torch.sqrt(v + eps)
def _scatter_add(tgt, idx, src, axis=0):
    return tgt.clone().index_add_(axis, idx, src)
def _segment_sum(src, seg, n):
    out = torch.zeros((n,) + src.shape[1:], dtype=src.dtype)
    return out.index_add_(0, seg, src)
def _pad(x, pw):
    flat = tuple(v for pair in reversed(pw) for v in pair)
    return torch.nn.functional.pad(x, flat)

kernel_name = 'standalone__weight_only_int_quip__sampling'

def setup_inputs():

    _w = (lambda a: (lambda t: t.to(torch.bfloat16) if t.is_floating_point() else t)(torch.as_tensor(a)))
    B, S, D, F = 32, 8, 1024, 3584
    G = 64 if 64 > 0 else D
    D = (D // G) * G
    ng = D // G
    bits = 4 if 4 > 0 else 4
    qmax = 1 << bits
    qw = torch.randint(0, qmax, (D, F)).to(torch.int32)
    U, _ = (lambda *_a, **_k: torch.linalg.qr(*[torch.as_tensor(_x).float() for _x in _a], **_k))((lambda *s: torch.randn(*s, dtype=torch.bfloat16) * 0.05)(D, D))
    V, _ = (lambda *_a, **_k: torch.linalg.qr(*[torch.as_tensor(_x).float() for _x in _a], **_k))((lambda *s: torch.randn(*s, dtype=torch.bfloat16) * 0.05)(F, F))
    return {
        "x": _w((lambda *s: torch.randn(*s, dtype=torch.bfloat16) * 0.05)(B, S, D)),
        "qw": _w(qw),
        "scales": _w(torch.abs((lambda *s: torch.randn(*s, dtype=torch.bfloat16) * 0.05)(ng, F)) * 0.02 + 0.005),
        "zeros": _w(torch.full((ng, F), qmax / 2.0, dtype=float)),
        "U": _w(U.to(float)),
        "V": _w(V.to(float)),
    }

def reference(x, qw, scales, zeros, U, V):
    B, S, D = x.shape
    ng, F = scales.shape
    G = D // ng
    s = (lambda x, n, axis: torch.repeat_interleave(x, n, dim=axis))(scales, G, axis=0)
    z = (lambda x, n, axis: torch.repeat_interleave(x, n, dim=axis))(zeros, G, axis=0)
    wq = ((lambda x, dt: x.to(dt))(qw, x.dtype) - z) * s
    xr = torch.einsum("bsd,de->bse", x, U)
    h  = torch.einsum("bse,ef->bsf", xr, wq)
    y  = torch.einsum("bsf,fg->bsg", h, V)
    return y
```

```asm
; @launch grid=(256,1,1) block=(256,1,1) lds=163840
.amdgcn_target "amdgcn-amd-amdhsa--gfx950"
.text
.globl standalone__weight_only_int_quip__sampling_kernel
.p2align 8
.type standalone__weight_only_int_quip__sampling_kernel,@function
standalone__weight_only_int_quip__sampling_kernel:
s_cmp_ge_u32 s2, 256
s_cbranch_scc1 L_end
s_load_dwordx16 s[4:19], s[0:1], 0
s_load_dwordx2 s[20:21], s[0:1], 64
v_lshrrev_b32 v1, 6, v0
s_and_b32 s56, s2, 7
v_readfirstlane_b32 s3, v1
v_and_b32 v1, 63, v0
s_lshr_b32 s57, s2, 3
v_lshlrev_b32 v2, 4, v1
v_and_b32 v3, 15, v1
v_lshrrev_b32 v4, 4, v1
s_cmp_ge_u32 s57, 28
s_cbranch_scc1 L_g1
s_cmp_lg_u32 s3, 3
s_cbranch_scc1 L_noipf
s_sub_u32 s61, s57, 26
s_cmp_ge_u32 s61, 2
s_cbranch_scc1 L_noipf
s_getpc_b64 s[96:97]
L_pc:
s_lshl_b32 s61, s61, 13
v_lshlrev_b32 v14, 7, v1
v_add_u32 v14, s61, v14
v_add_u32 v15, 0x4000, v14
v_min_u32 v15, L_codeend-L_pc-4, v15
global_load_dword a255, v15, s[96:97]
global_load_dword a255, v14, s[96:97]
L_noipf:
s_and_b32 s64, s57, 1
s_lshl_b32 s58, s64, 1
s_bfe_u32 s62, s57, 0x10001
s_add_u32 s58, s58, s62
s_lshr_b32 s59, s57, 2
s_mul_i32 s61, s56, 7
s_add_u32 s59, s59, s61
v_lshrrev_b32 v8, 2, v1
v_lshlrev_b32 v8, 11, v8
v_and_b32 v9, 3, v1
v_lshl_add_u32 v8, v9, 7, v8
v_lshlrev_b32 v9, 11, v1
v_mul_u32_u24 v5, 57344, v4
v_lshl_add_u32 v5, v3, 4, v5
s_mul_i32 s61, s3, 28
s_add_u32 s61, s61, s57
s_mul_i32 s62, s61, 43
s_lshr_b32 s62, s62, 8
s_mul_i32 s63, s62, 6
s_sub_u32 s61, s61, s63
s_add_u32 s65, s62, 1
s_lshl_b32 s62, s65, 2
s_add_u32 s62, s62, s61
s_lshl_b32 s62, s62, 15
s_lshr_b32 s63, s56, 1
s_lshl_b32 s63, s63, 9
s_add_u32 s62, s62, s63
s_and_b32 s63, s56, 1
s_lshl_b32 s63, s63, 1
s_add_u32 s63, s63, s61
s_sub_u32 s63, s63, 4
s_lshl_b32 s63, s63, 17
s_lshl_b32 s60, s65, 7
s_add_u32 s63, s63, s60
s_cmp_lt_u32 s61, 4
s_cselect_b32 s23, s62, s63
s_cselect_b64 vcc, -1, 0
v_cndmask_b32 v13, v9, v8, vcc
s_waitcnt lgkmcnt(0)
s_cselect_b32 s40, s12, s4
s_cselect_b32 s41, s13, s5
s_mov_b32 s42, 524288
s_cselect_b32 s42, 2097152, s42
s_mov_b32 s43, 0x20000
s_mov_b32 s26, s23
s_mov_b32 s27, s65
s_sub_u32 s61, s27, 0
s_cmp_ge_u32 s61, 10
s_cbranch_scc1 L_td0
buffer_load_dword a255, v13, s[40:43], s26 offen
L_td0:
s_lshl_b32 s61, s64, 7
s_add_u32 s61, s61, 3145728
s_add_u32 s22, s20, s61
s_addc_u32 s23, s21, 0
s_load_dword s60, s[22:23], 0
s_mov_b32 s28, s6
s_mov_b32 s29, s7
s_mov_b32 s30, 14680064
s_mov_b32 s31, 0x20000
s_mov_b32 s32, s8
s_mov_b32 s33, s9
s_mov_b32 s34, 114688
s_mov_b32 s35, 0x20000
s_mov_b32 s36, s10
s_mov_b32 s37, s11
s_mov_b32 s38, 114688
s_mov_b32 s39, 0x20000
s_mul_i32 s7, s3, 3670016
s_lshl_b32 s62, s59, 8
s_add_u32 s7, s7, s62
s_mul_i32 s8, s3, 28672
s_lshl_b32 s62, s59, 7
s_add_u32 s8, s8, s62
v_lshlrev_b32 v7, 3, v3
s_add_u32 s61, s58, 0
s_and_b32 s61, s61, 3
s_mul_i32 s61, s61, 7168
s_add_u32 s62, s8, s61
buffer_load_dwordx2 v[144:145], v7, s[32:35], s62 offen
buffer_load_dwordx2 v[146:147], v7, s[36:39], s62 offen
s_add_u32 s61, s58, 1
s_and_b32 s61, s61, 3
s_mul_i32 s61, s61, 7168
s_add_u32 s62, s8, s61
buffer_load_dwordx2 v[148:149], v7, s[32:35], s62 offen
buffer_load_dwordx2 v[150:151], v7, s[36:39], s62 offen
s_add_u32 s61, s58, 2
s_and_b32 s61, s61, 3
s_mul_i32 s61, s61, 7168
s_add_u32 s62, s8, s61
buffer_load_dwordx2 v[152:153], v7, s[32:35], s62 offen
buffer_load_dwordx2 v[154:155], v7, s[36:39], s62 offen
s_add_u32 s61, s58, 3
s_and_b32 s61, s61, 3
s_mul_i32 s61, s61, 7168
s_add_u32 s62, s8, s61
buffer_load_dwordx2 v[156:157], v7, s[32:35], s62 offen
buffer_load_dwordx2 v[158:159], v7, s[36:39], s62 offen
s_add_u32 s61, s58, 0
s_and_b32 s61, s61, 3
s_mul_i32 s61, s61, 917504
s_add_u32 s61, s61, s7
s_add_u32 s62, s61, 0
buffer_load_dwordx4 v[160:163], v5, s[28:31], s62 offen
s_add_u32 s62, s61, 14336
buffer_load_dwordx4 v[164:167], v5, s[28:31], s62 offen
s_add_u32 s62, s61, 28672
buffer_load_dwordx4 v[168:171], v5, s[28:31], s62 offen
s_add_u32 s62, s61, 43008
buffer_load_dwordx4 v[172:175], v5, s[28:31], s62 offen
s_add_u32 s62, s61, 229376
buffer_load_dwordx4 v[176:179], v5, s[28:31], s62 offen
s_add_u32 s62, s61, 243712
s_waitcnt vmcnt(4)
buffer_load_dwordx4 v[180:183], v5, s[28:31], s62 offen
s_add_u32 s62, s61, 258048
s_waitcnt vmcnt(4)
buffer_load_dwordx4 v[184:187], v5, s[28:31], s62 offen
s_add_u32 s62, s61, 272384
s_waitcnt vmcnt(4)
buffer_load_dwordx4 v[188:191], v5, s[28:31], s62 offen
s_sub_u32 s61, s27, 10
s_cmp_ge_u32 s61, 6
s_cbranch_scc1 L_td1
buffer_load_dword a255, v13, s[40:43], s26 offen
L_td1:
s_mov_b32 s44, s14
s_mov_b32 s45, s15
s_mov_b32 s46, 25690112
s_mov_b32 s47, 0x20000
s_mov_b32 s48, s16
s_mov_b32 s49, s17
s_mov_b32 s50, 1835008
s_mov_b32 s51, 0x20000
s_mov_b32 s52, s20
s_mov_b32 s53, s21
s_mov_b32 s54, 268435456
s_mov_b32 s55, 0x20000
s_lshr_b32 s9, s56, 1
s_and_b32 s61, s56, 1
s_mul_i32 s11, s61, 14
s_lshr_b32 s61, s57, 1
s_add_u32 s11, s11, s61
s_mul_i32 s65, s64, 28
s_add_u32 s65, s65, s11
s_lshl_b32 s12, s65, 18
s_lshl_b32 s61, s9, 14
s_add_u32 s12, s12, s61
s_lshl_b32 s61, s3, 12
s_add_u32 s12, s12, s61
s_add_u32 s12, s12, 16777216
s_add_u32 s61, s58, 0
s_and_b32 s61, s61, 3
s_mul_i32 s61, s61, 917504
s_add_u32 s61, s61, s7
s_add_u32 s62, s61, 458752
s_waitcnt vmcnt(4)
buffer_load_dwordx4 v[192:195], v5, s[28:31], s62 offen
s_add_u32 s62, s61, 473088
s_waitcnt vmcnt(4)
buffer_load_dwordx4 v[196:199], v5, s[28:31], s62 offen
s_add_u32 s62, s61, 487424
s_waitcnt vmcnt(4)
buffer_load_dwordx4 v[200:203], v5, s[28:31], s62 offen
s_add_u32 s62, s61, 501760
s_waitcnt vmcnt(4)
buffer_load_dwordx4 v[204:207], v5, s[28:31], s62 offen
s_add_u32 s62, s61, 688128
s_waitcnt vmcnt(4)
buffer_load_dwordx4 v[208:211], v5, s[28:31], s62 offen
s_add_u32 s62, s61, 702464
s_waitcnt vmcnt(4)
buffer_load_dwordx4 v[212:215], v5, s[28:31], s62 offen
s_add_u32 s62, s61, 716800
s_waitcnt vmcnt(4)
buffer_load_dwordx4 v[216:219], v5, s[28:31], s62 offen
s_add_u32 s62, s61, 731136
s_waitcnt vmcnt(4)
buffer_load_dwordx4 v[220:223], v5, s[28:31], s62 offen
s_sub_u32 s61, s27, 16
s_cmp_ge_u32 s61, 0
s_cbranch_scc1 L_td2
buffer_load_dword a255, v13, s[40:43], s26 offen
L_td2:
v_lshlrev_b32 v6, 2, v4
v_xor_b32 v6, v6, v3
v_lshlrev_b32 v6, 4, v6
v_mul_u32_u24 v8, 7168, v4
v_add_u32 v6, v6, v8
s_mul_i32 s14, s9, 896
s_lshl_b32 s61, s3, 2
s_add_u32 s14, s14, s61
s_mul_i32 s14, s14, 7168
s_lshl_b32 s61, s11, 8
s_add_u32 s14, s14, s61
s_mul_i32 s61, s64, 802816
s_sub_u32 s15, s14, s61
s_add_u32 s14, s14, s61
s_lshl_b32 s18, s3, 10
s_mul_i32 s61, s64, 28672
s_add_u32 s16, s18, s61
s_sub_u32 s17, s18, s61
s_lshl_b32 s19, s58, 5
s_lshl_b32 s61, s3, 3
s_add_u32 s19, s19, s61
s_lshl_b32 s19, s19, 12
s_add_u32 s61, s58, 0
s_and_b32 s61, s61, 3
s_lshl_b32 s61, s61, 13
s_add_u32 s61, s61, s19
s_add_u32 s24, s61, 0
s_add_u32 s61, s58, 0
s_and_b32 s61, s61, 3
s_lshl_b32 s61, s61, 13
s_add_u32 s61, s61, s19
s_add_u32 s25, s61, 4096
s_add_u32 s61, s58, 1
s_and_b32 s61, s61, 3
s_lshl_b32 s61, s61, 13
s_add_u32 s61, s61, s19
s_add_u32 s26, s61, 0
s_add_u32 s61, s58, 1
s_and_b32 s61, s61, 3
s_lshl_b32 s61, s61, 13
s_add_u32 s61, s61, s19
s_add_u32 s27, s61, 4096
s_add_u32 s61, s58, 2
s_and_b32 s61, s61, 3
s_lshl_b32 s61, s61, 13
s_add_u32 s61, s61, s19
s_add_u32 s40, s61, 0
s_add_u32 s61, s58, 2
s_and_b32 s61, s61, 3
s_lshl_b32 s61, s61, 13
s_add_u32 s61, s61, s19
s_add_u32 s41, s61, 4096
s_add_u32 s61, s58, 3
s_and_b32 s61, s61, 3
s_lshl_b32 s61, s61, 13
s_add_u32 s61, s61, s19
s_add_u32 s42, s61, 0
s_add_u32 s61, s58, 3
s_and_b32 s61, s61, 3
s_lshl_b32 s61, s61, 13
s_add_u32 s61, s61, s19
s_add_u32 s43, s61, 4096
s_lshr_b32 s10, s57, 2
s_add_u32 s10, s10, s3
s_and_b32 s10, s10, 3
v_and_b32 v0, 3, v1
v_lshlrev_b32 v0, 5, v0
s_lshl_b32 s61, s64, 2
s_add_u32 s61, s61, s3
s_lshl_b32 s61, s61, 7
s_add_u32 s20, s61, 3211264
s_lshl_b32 s61, s56, 12
s_add_u32 s20, s20, s61
s_waitcnt lgkmcnt(0)
s_add_u32 s60, s60, 2654435769
s_add_u32 m0, s16, 0
s_add_u32 s62, s14, 0
buffer_load_dwordx4 v6, s[44:47], s62 offen lds
s_add_u32 m0, s16, 4096
s_add_u32 s62, s14, 114688
buffer_load_dwordx4 v6, s[44:47], s62 offen lds
s_add_u32 m0, s16, 8192
s_add_u32 s62, s14, 229376
buffer_load_dwordx4 v6, s[44:47], s62 offen lds
s_add_u32 m0, s16, 12288
s_add_u32 s62, s14, 344064
buffer_load_dwordx4 v6, s[44:47], s62 offen lds
v_lshlrev_b32 v8, 16, v144
v_and_b32 v9, 0xffff0000, v144
v_lshlrev_b32 v10, 16, v145
v_and_b32 v11, 0xffff0000, v145
v_lshlrev_b32 v12, 16, v146
v_and_b32 v13, 0xffff0000, v146
v_lshlrev_b32 v14, 16, v147
v_and_b32 v15, 0xffff0000, v147
v_mul_f32 v12, -v12, v8
v_mul_f32 v13, -v13, v9
v_mul_f32 v14, -v14, v10
v_mul_f32 v15, -v15, v11
v_cvt_f32_i32 v160, v160
v_cvt_f32_i32 v161, v161
v_cvt_f32_i32 v162, v162
v_cvt_f32_i32 v163, v163
v_cvt_f32_i32 v164, v164
v_cvt_f32_i32 v165, v165
v_cvt_f32_i32 v166, v166
v_cvt_f32_i32 v167, v167
v_cvt_f32_i32 v168, v168
v_cvt_f32_i32 v169, v169
v_cvt_f32_i32 v170, v170
v_cvt_f32_i32 v171, v171
v_cvt_f32_i32 v172, v172
v_cvt_f32_i32 v173, v173
v_cvt_f32_i32 v174, v174
v_cvt_f32_i32 v175, v175
v_cvt_f32_i32 v176, v176
v_cvt_f32_i32 v177, v177
v_cvt_f32_i32 v178, v178
v_cvt_f32_i32 v179, v179
v_cvt_f32_i32 v180, v180
v_cvt_f32_i32 v181, v181
v_cvt_f32_i32 v182, v182
v_cvt_f32_i32 v183, v183
v_cvt_f32_i32 v184, v184
v_cvt_f32_i32 v185, v185
v_cvt_f32_i32 v186, v186
v_cvt_f32_i32 v187, v187
v_cvt_f32_i32 v188, v188
v_cvt_f32_i32 v189, v189
v_cvt_f32_i32 v190, v190
v_cvt_f32_i32 v191, v191
.p2align 3
v_pk_fma_f32 v[160:161], v[160:161], v[8:9], v[12:13]
v_pk_fma_f32 v[162:163], v[162:163], v[10:11], v[14:15]
v_pk_fma_f32 v[164:165], v[164:165], v[8:9], v[12:13]
v_pk_fma_f32 v[166:167], v[166:167], v[10:11], v[14:15]
v_pk_fma_f32 v[168:169], v[168:169], v[8:9], v[12:13]
v_pk_fma_f32 v[170:171], v[170:171], v[10:11], v[14:15]
v_pk_fma_f32 v[172:173], v[172:173], v[8:9], v[12:13]
v_pk_fma_f32 v[174:175], v[174:175], v[10:11], v[14:15]
v_pk_fma_f32 v[176:177], v[176:177], v[8:9], v[12:13]
v_pk_fma_f32 v[178:179], v[178:179], v[10:11], v[14:15]
v_pk_fma_f32 v[180:181], v[180:181], v[8:9], v[12:13]
v_pk_fma_f32 v[182:183], v[182:183], v[10:11], v[14:15]
v_pk_fma_f32 v[184:185], v[184:185], v[8:9], v[12:13]
v_pk_fma_f32 v[186:187], v[186:187], v[10:11], v[14:15]
v_pk_fma_f32 v[188:189], v[188:189], v[8:9], v[12:13]
v_pk_fma_f32 v[190:191], v[190:191], v[10:11], v[14:15]
v_cvt_pk_bf16_f32 v16, v160, v164
v_cvt_pk_bf16_f32 v17, v168, v172
v_cvt_pk_bf16_f32 v18, v176, v180
v_cvt_pk_bf16_f32 v19, v184, v188
v_cvt_pk_bf16_f32 v20, v161, v165
v_cvt_pk_bf16_f32 v21, v169, v173
v_cvt_pk_bf16_f32 v22, v177, v181
v_cvt_pk_bf16_f32 v23, v185, v189
v_cvt_pk_bf16_f32 v24, v162, v166
v_cvt_pk_bf16_f32 v25, v170, v174
v_cvt_pk_bf16_f32 v26, v178, v182
v_cvt_pk_bf16_f32 v27, v186, v190
v_cvt_pk_bf16_f32 v28, v163, v167
v_cvt_pk_bf16_f32 v29, v171, v175
v_cvt_pk_bf16_f32 v30, v179, v183
v_cvt_pk_bf16_f32 v31, v187, v191
s_waitcnt vmcnt(4)
v_cvt_f32_i32 v192, v192
v_cvt_f32_i32 v193, v193
v_cvt_f32_i32 v194, v194
v_cvt_f32_i32 v195, v195
v_cvt_f32_i32 v196, v196
v_cvt_f32_i32 v197, v197
v_cvt_f32_i32 v198, v198
v_cvt_f32_i32 v199, v199
v_cvt_f32_i32 v200, v200
v_cvt_f32_i32 v201, v201
v_cvt_f32_i32 v202, v202
v_cvt_f32_i32 v203, v203
v_cvt_f32_i32 v204, v204
v_cvt_f32_i32 v205, v205
v_cvt_f32_i32 v206, v206
v_cvt_f32_i32 v207, v207
v_cvt_f32_i32 v208, v208
v_cvt_f32_i32 v209, v209
v_cvt_f32_i32 v210, v210
v_cvt_f32_i32 v211, v211
v_cvt_f32_i32 v212, v212
v_cvt_f32_i32 v213, v213
v_cvt_f32_i32 v214, v214
v_cvt_f32_i32 v215, v215
v_cvt_f32_i32 v216, v216
v_cvt_f32_i32 v217, v217
v_cvt_f32_i32 v218, v218
v_cvt_f32_i32 v219, v219
v_cvt_f32_i32 v220, v220
v_cvt_f32_i32 v221, v221
v_cvt_f32_i32 v222, v222
v_cvt_f32_i32 v223, v223
.p2align 3
v_pk_fma_f32 v[192:193], v[192:193], v[8:9], v[12:13]
v_pk_fma_f32 v[194:195], v[194:195], v[10:11], v[14:15]
v_pk_fma_f32 v[196:197], v[196:197], v[8:9], v[12:13]
v_pk_fma_f32 v[198:199], v[198:199], v[10:11], v[14:15]
v_pk_fma_f32 v[200:201], v[200:201], v[8:9], v[12:13]
v_pk_fma_f32 v[202:203], v[202:203], v[10:11], v[14:15]
v_pk_fma_f32 v[204:205], v[204:205], v[8:9], v[12:13]
v_pk_fma_f32 v[206:207], v[206:207], v[10:11], v[14:15]
v_pk_fma_f32 v[208:209], v[208:209], v[8:9], v[12:13]
v_pk_fma_f32 v[210:211], v[210:211], v[10:11], v[14:15]
v_pk_fma_f32 v[212:213], v[212:213], v[8:9], v[12:13]
v_pk_fma_f32 v[214:215], v[214:215], v[10:11], v[14:15]
v_pk_fma_f32 v[216:217], v[216:217], v[8:9], v[12:13]
v_pk_fma_f32 v[218:219], v[218:219], v[10:11], v[14:15]
v_pk_fma_f32 v[220:221], v[220:221], v[8:9], v[12:13]
v_pk_fma_f32 v[222:223], v[222:223], v[10:11], v[14:15]
v_cvt_pk_bf16_f32 v32, v192, v196
v_cvt_pk_bf16_f32 v33, v200, v204
v_cvt_pk_bf16_f32 v34, v208, v212
v_cvt_pk_bf16_f32 v35, v216, v220
v_cvt_pk_bf16_f32 v36, v193, v197
v_cvt_pk_bf16_f32 v37, v201, v205
v_cvt_pk_bf16_f32 v38, v209, v213
v_cvt_pk_bf16_f32 v39, v217, v221
v_cvt_pk_bf16_f32 v40, v194, v198
v_cvt_pk_bf16_f32 v41, v202, v206
v_cvt_pk_bf16_f32 v42, v210, v214
v_cvt_pk_bf16_f32 v43, v218, v222
v_cvt_pk_bf16_f32 v44, v195, v199
v_cvt_pk_bf16_f32 v45, v203, v207
v_cvt_pk_bf16_f32 v46, v211, v215
v_cvt_pk_bf16_f32 v47, v219, v223
s_add_u32 s61, s58, 1
s_and_b32 s61, s61, 3
s_mul_i32 s61, s61, 917504
s_add_u32 s61, s61, s7
s_add_u32 s62, s61, 0
buffer_load_dwordx4 v[224:227], v5, s[28:31], s62 offen
s_add_u32 s62, s61, 14336
buffer_load_dwordx4 v[228:231], v5, s[28:31], s62 offen
s_add_u32 s62, s61, 28672
buffer_load_dwordx4 v[232:235], v5, s[28:31], s62 offen
s_add_u32 s62, s61, 43008
buffer_load_dwordx4 v[236:239], v5, s[28:31], s62 offen
s_add_u32 s62, s61, 229376
buffer_load_dwordx4 v[240:243], v5, s[28:31], s62 offen
s_add_u32 s62, s61, 243712
buffer_load_dwordx4 v[244:247], v5, s[28:31], s62 offen
s_add_u32 s62, s61, 258048
buffer_load_dwordx4 v[248:251], v5, s[28:31], s62 offen
s_add_u32 s62, s61, 272384
buffer_load_dwordx4 v[252:255], v5, s[28:31], s62 offen
s_add_u32 s61, s58, 1
s_and_b32 s61, s61, 3
s_mul_i32 s61, s61, 917504
s_add_u32 s61, s61, s7
s_add_u32 s62, s61, 458752
buffer_load_dwordx4 v[160:163], v5, s[28:31], s62 offen
s_add_u32 s62, s61, 473088
buffer_load_dwordx4 v[164:167], v5, s[28:31], s62 offen
s_add_u32 s62, s61, 487424
buffer_load_dwordx4 v[168:171], v5, s[28:31], s62 offen
s_add_u32 s62, s61, 501760
buffer_load_dwordx4 v[172:175], v5, s[28:31], s62 offen
s_add_u32 s62, s61, 688128
buffer_load_dwordx4 v[176:179], v5, s[28:31], s62 offen
s_add_u32 s62, s61, 702464
buffer_load_dwordx4 v[180:183], v5, s[28:31], s62 offen
s_add_u32 s62, s61, 716800
buffer_load_dwordx4 v[184:187], v5, s[28:31], s62 offen
s_add_u32 s62, s61, 731136
buffer_load_dwordx4 v[188:191], v5, s[28:31], s62 offen
s_add_u32 s61, s58, 2
s_and_b32 s61, s61, 3
s_mul_i32 s61, s61, 917504
s_add_u32 s61, s61, s7
s_add_u32 s62, s61, 0
buffer_load_dwordx4 v[192:195], v5, s[28:31], s62 offen
s_add_u32 s62, s61, 14336
buffer_load_dwordx4 v[196:199], v5, s[28:31], s62 offen
s_add_u32 s62, s61, 28672
buffer_load_dwordx4 v[200:203], v5, s[28:31], s62 offen
s_add_u32 s62, s61, 43008
buffer_load_dwordx4 v[204:207], v5, s[28:31], s62 offen
s_add_u32 s62, s61, 229376
buffer_load_dwordx4 v[208:211], v5, s[28:31], s62 offen
s_add_u32 s62, s61, 243712
buffer_load_dwordx4 v[212:215], v5, s[28:31], s62 offen
s_add_u32 s62, s61, 258048
buffer_load_dwordx4 v[216:219], v5, s[28:31], s62 offen
s_add_u32 s62, s61, 272384
buffer_load_dwordx4 v[220:223], v5, s[28:31], s62 offen
s_waitcnt vmcnt(16)
v_lshlrev_b32 v8, 16, v148
v_and_b32 v9, 0xffff0000, v148
v_lshlrev_b32 v10, 16, v149
v_and_b32 v11, 0xffff0000, v149
v_lshlrev_b32 v12, 16, v150
v_and_b32 v13, 0xffff0000, v150
v_lshlrev_b32 v14, 16, v151
v_and_b32 v15, 0xffff0000, v151
v_mul_f32 v12, -v12, v8
v_mul_f32 v13, -v13, v9
v_mul_f32 v14, -v14, v10
v_mul_f32 v15, -v15, v11
v_cvt_f32_i32 v224, v224
v_cvt_f32_i32 v225, v225
v_cvt_f32_i32 v226, v226
v_cvt_f32_i32 v227, v227
v_cvt_f32_i32 v228, v228
v_cvt_f32_i32 v229, v229
v_cvt_f32_i32 v230, v230
v_cvt_f32_i32 v231, v231
v_cvt_f32_i32 v232, v232
v_cvt_f32_i32 v233, v233
v_cvt_f32_i32 v234, v234
v_cvt_f32_i32 v235, v235
v_cvt_f32_i32 v236, v236
v_cvt_f32_i32 v237, v237
v_cvt_f32_i32 v238, v238
v_cvt_f32_i32 v239, v239
v_cvt_f32_i32 v240, v240
v_cvt_f32_i32 v241, v241
v_cvt_f32_i32 v242, v242
v_cvt_f32_i32 v243, v243
v_cvt_f32_i32 v244, v244
v_cvt_f32_i32 v245, v245
v_cvt_f32_i32 v246, v246
v_cvt_f32_i32 v247, v247
v_cvt_f32_i32 v248, v248
v_cvt_f32_i32 v249, v249
v_cvt_f32_i32 v250, v250
v_cvt_f32_i32 v251, v251
v_cvt_f32_i32 v252, v252
v_cvt_f32_i32 v253, v253
v_cvt_f32_i32 v254, v254
v_cvt_f32_i32 v255, v255
.p2align 3
v_pk_fma_f32 v[224:225], v[224:225], v[8:9], v[12:13]
v_pk_fma_f32 v[226:227], v[226:227], v[10:11], v[14:15]
v_pk_fma_f32 v[228:229], v[228:229], v[8:9], v[12:13]
v_pk_fma_f32 v[230:231], v[230:231], v[10:11], v[14:15]
v_pk_fma_f32 v[232:233], v[232:233], v[8:9], v[12:13]
v_pk_fma_f32 v[234:235], v[234:235], v[10:11], v[14:15]
v_pk_fma_f32 v[236:237], v[236:237], v[8:9], v[12:13]
v_pk_fma_f32 v[238:239], v[238:239], v[10:11], v[14:15]
v_pk_fma_f32 v[240:241], v[240:241], v[8:9], v[12:13]
v_pk_fma_f32 v[242:243], v[242:243], v[10:11], v[14:15]
v_pk_fma_f32 v[244:245], v[244:245], v[8:9], v[12:13]
v_pk_fma_f32 v[246:247], v[246:247], v[10:11], v[14:15]
v_pk_fma_f32 v[248:249], v[248:249], v[8:9], v[12:13]
v_pk_fma_f32 v[250:251], v[250:251], v[10:11], v[14:15]
v_pk_fma_f32 v[252:253], v[252:253], v[8:9], v[12:13]
v_pk_fma_f32 v[254:255], v[254:255], v[10:11], v[14:15]
v_cvt_pk_bf16_f32 v48, v224, v228
v_cvt_pk_bf16_f32 v49, v232, v236
v_cvt_pk_bf16_f32 v50, v240, v244
v_cvt_pk_bf16_f32 v51, v248, v252
v_cvt_pk_bf16_f32 v52, v225, v229
v_cvt_pk_bf16_f32 v53, v233, v237
v_cvt_pk_bf16_f32 v54, v241, v245
v_cvt_pk_bf16_f32 v55, v249, v253
v_cvt_pk_bf16_f32 v56, v226, v230
v_cvt_pk_bf16_f32 v57, v234, v238
v_cvt_pk_bf16_f32 v58, v242, v246
v_cvt_pk_bf16_f32 v59, v250, v254
v_cvt_pk_bf16_f32 v60, v227, v231
v_cvt_pk_bf16_f32 v61, v235, v239
v_cvt_pk_bf16_f32 v62, v243, v247
v_cvt_pk_bf16_f32 v63, v251, v255
s_add_u32 s61, s58, 2
s_and_b32 s61, s61, 3
s_mul_i32 s61, s61, 917504
s_add_u32 s61, s61, s7
s_add_u32 s62, s61, 458752
buffer_load_dwordx4 v[224:227], v5, s[28:31], s62 offen
s_add_u32 s62, s61, 473088
buffer_load_dwordx4 v[228:231], v5, s[28:31], s62 offen
s_add_u32 s62, s61, 487424
buffer_load_dwordx4 v[232:235], v5, s[28:31], s62 offen
s_add_u32 s62, s61, 501760
buffer_load_dwordx4 v[236:239], v5, s[28:31], s62 offen
s_add_u32 s62, s61, 688128
buffer_load_dwordx4 v[240:243], v5, s[28:31], s62 offen
s_add_u32 s62, s61, 702464
buffer_load_dwordx4 v[244:247], v5, s[28:31], s62 offen
s_add_u32 s62, s61, 716800
buffer_load_dwordx4 v[248:251], v5, s[28:31], s62 offen
s_add_u32 s62, s61, 731136
buffer_load_dwordx4 v[252:255], v5, s[28:31], s62 offen
s_waitcnt vmcnt(16)
v_cvt_f32_i32 v160, v160
v_cvt_f32_i32 v161, v161
v_cvt_f32_i32 v162, v162
v_cvt_f32_i32 v163, v163
v_cvt_f32_i32 v164, v164
v_cvt_f32_i32 v165, v165
v_cvt_f32_i32 v166, v166
v_cvt_f32_i32 v167, v167
v_cvt_f32_i32 v168, v168
v_cvt_f32_i32 v169, v169
v_cvt_f32_i32 v170, v170
v_cvt_f32_i32 v171, v171
v_cvt_f32_i32 v172, v172
v_cvt_f32_i32 v173, v173
v_cvt_f32_i32 v174, v174
v_cvt_f32_i32 v175, v175
v_cvt_f32_i32 v176, v176
v_cvt_f32_i32 v177, v177
v_cvt_f32_i32 v178, v178
v_cvt_f32_i32 v179, v179
v_cvt_f32_i32 v180, v180
v_cvt_f32_i32 v181, v181
v_cvt_f32_i32 v182, v182
v_cvt_f32_i32 v183, v183
v_cvt_f32_i32 v184, v184
v_cvt_f32_i32 v185, v185
v_cvt_f32_i32 v186, v186
v_cvt_f32_i32 v187, v187
v_cvt_f32_i32 v188, v188
v_cvt_f32_i32 v189, v189
v_cvt_f32_i32 v190, v190
v_cvt_f32_i32 v191, v191
.p2align 3
v_pk_fma_f32 v[160:161], v[160:161], v[8:9], v[12:13]
v_pk_fma_f32 v[162:163], v[162:163], v[10:11], v[14:15]
v_pk_fma_f32 v[164:165], v[164:165], v[8:9], v[12:13]
v_pk_fma_f32 v[166:167], v[166:167], v[10:11], v[14:15]
v_pk_fma_f32 v[168:169], v[168:169], v[8:9], v[12:13]
v_pk_fma_f32 v[170:171], v[170:171], v[10:11], v[14:15]
v_pk_fma_f32 v[172:173], v[172:173], v[8:9], v[12:13]
v_pk_fma_f32 v[174:175], v[174:175], v[10:11], v[14:15]
v_pk_fma_f32 v[176:177], v[176:177], v[8:9], v[12:13]
v_pk_fma_f32 v[178:179], v[178:179], v[10:11], v[14:15]
v_pk_fma_f32 v[180:181], v[180:181], v[8:9], v[12:13]
v_pk_fma_f32 v[182:183], v[182:183], v[10:11], v[14:15]
v_pk_fma_f32 v[184:185], v[184:185], v[8:9], v[12:13]
v_pk_fma_f32 v[186:187], v[186:187], v[10:11], v[14:15]
v_pk_fma_f32 v[188:189], v[188:189], v[8:9], v[12:13]
v_pk_fma_f32 v[190:191], v[190:191], v[10:11], v[14:15]
v_cvt_pk_bf16_f32 v64, v160, v164
v_cvt_pk_bf16_f32 v65, v168, v172
v_cvt_pk_bf16_f32 v66, v176, v180
v_cvt_pk_bf16_f32 v67, v184, v188
v_cvt_pk_bf16_f32 v68, v161, v165
v_cvt_pk_bf16_f32 v69, v169, v173
v_cvt_pk_bf16_f32 v70, v177, v181
v_cvt_pk_bf16_f32 v71, v185, v189
v_cvt_pk_bf16_f32 v72, v162, v166
v_cvt_pk_bf16_f32 v73, v170, v174
v_cvt_pk_bf16_f32 v74, v178, v182
v_cvt_pk_bf16_f32 v75, v186, v190
v_cvt_pk_bf16_f32 v76, v163, v167
v_cvt_pk_bf16_f32 v77, v171, v175
v_cvt_pk_bf16_f32 v78, v179, v183
v_cvt_pk_bf16_f32 v79, v187, v191
s_add_u32 s61, s58, 3
s_and_b32 s61, s61, 3
s_mul_i32 s61, s61, 917504
s_add_u32 s61, s61, s7
s_add_u32 s62, s61, 0
buffer_load_dwordx4 v[160:163], v5, s[28:31], s62 offen
s_add_u32 s62, s61, 14336
buffer_load_dwordx4 v[164:167], v5, s[28:31], s62 offen
s_add_u32 s62, s61, 28672
buffer_load_dwordx4 v[168:171], v5, s[28:31], s62 offen
s_add_u32 s62, s61, 43008
buffer_load_dwordx4 v[172:175], v5, s[28:31], s62 offen
s_add_u32 s62, s61, 229376
buffer_load_dwordx4 v[176:179], v5, s[28:31], s62 offen
s_add_u32 s62, s61, 243712
buffer_load_dwordx4 v[180:183], v5, s[28:31], s62 offen
s_add_u32 s62, s61, 258048
buffer_load_dwordx4 v[184:187], v5, s[28:31], s62 offen
s_add_u32 s62, s61, 272384
buffer_load_dwordx4 v[188:191], v5, s[28:31], s62 offen
s_waitcnt vmcnt(16)
v_lshlrev_b32 v8, 16, v152
v_and_b32 v9, 0xffff0000, v152
v_lshlrev_b32 v10, 16, v153
v_and_b32 v11, 0xffff0000, v153
v_lshlrev_b32 v12, 16, v154
v_and_b32 v13, 0xffff0000, v154
v_lshlrev_b32 v14, 16, v155
v_and_b32 v15, 0xffff0000, v155
v_mul_f32 v12, -v12, v8
v_mul_f32 v13, -v13, v9
v_mul_f32 v14, -v14, v10
v_mul_f32 v15, -v15, v11
v_cvt_f32_i32 v192, v192
v_cvt_f32_i32 v193, v193
v_cvt_f32_i32 v194, v194
v_cvt_f32_i32 v195, v195
v_cvt_f32_i32 v196, v196
v_cvt_f32_i32 v197, v197
v_cvt_f32_i32 v198, v198
v_cvt_f32_i32 v199, v199
v_cvt_f32_i32 v200, v200
v_cvt_f32_i32 v201, v201
v_cvt_f32_i32 v202, v202
v_cvt_f32_i32 v203, v203
v_cvt_f32_i32 v204, v204
v_cvt_f32_i32 v205, v205
v_cvt_f32_i32 v206, v206
v_cvt_f32_i32 v207, v207
v_cvt_f32_i32 v208, v208
v_cvt_f32_i32 v209, v209
v_cvt_f32_i32 v210, v210
v_cvt_f32_i32 v211, v211
v_cvt_f32_i32 v212, v212
v_cvt_f32_i32 v213, v213
v_cvt_f32_i32 v214, v214
v_cvt_f32_i32 v215, v215
v_cvt_f32_i32 v216, v216
v_cvt_f32_i32 v217, v217
v_cvt_f32_i32 v218, v218
v_cvt_f32_i32 v219, v219
v_cvt_f32_i32 v220, v220
v_cvt_f32_i32 v221, v221
v_cvt_f32_i32 v222, v222
v_cvt_f32_i32 v223, v223
.p2align 3
v_pk_fma_f32 v[192:193], v[192:193], v[8:9], v[12:13]
v_pk_fma_f32 v[194:195], v[194:195], v[10:11], v[14:15]
v_pk_fma_f32 v[196:197], v[196:197], v[8:9], v[12:13]
v_pk_fma_f32 v[198:199], v[198:199], v[10:11], v[14:15]
v_pk_fma_f32 v[200:201], v[200:201], v[8:9], v[12:13]
v_pk_fma_f32 v[202:203], v[202:203], v[10:11], v[14:15]
v_pk_fma_f32 v[204:205], v[204:205], v[8:9], v[12:13]
v_pk_fma_f32 v[206:207], v[206:207], v[10:11], v[14:15]
v_pk_fma_f32 v[208:209], v[208:209], v[8:9], v[12:13]
v_pk_fma_f32 v[210:211], v[210:211], v[10:11], v[14:15]
v_pk_fma_f32 v[212:213], v[212:213], v[8:9], v[12:13]
v_pk_fma_f32 v[214:215], v[214:215], v[10:11], v[14:15]
v_pk_fma_f32 v[216:217], v[216:217], v[8:9], v[12:13]
v_pk_fma_f32 v[218:219], v[218:219], v[10:11], v[14:15]
v_pk_fma_f32 v[220:221], v[220:221], v[8:9], v[12:13]
v_pk_fma_f32 v[222:223], v[222:223], v[10:11], v[14:15]
v_cvt_pk_bf16_f32 v80, v192, v196
v_cvt_pk_bf16_f32 v81, v200, v204
v_cvt_pk_bf16_f32 v82, v208, v212
v_cvt_pk_bf16_f32 v83, v216, v220
v_cvt_pk_bf16_f32 v84, v193, v197
v_cvt_pk_bf16_f32 v85, v201, v205
v_cvt_pk_bf16_f32 v86, v209, v213
v_cvt_pk_bf16_f32 v87, v217, v221
v_cvt_pk_bf16_f32 v88, v194, v198
v_cvt_pk_bf16_f32 v89, v202, v206
v_cvt_pk_bf16_f32 v90, v210, v214
v_cvt_pk_bf16_f32 v91, v218, v222
v_cvt_pk_bf16_f32 v92, v195, v199
v_cvt_pk_bf16_f32 v93, v203, v207
v_cvt_pk_bf16_f32 v94, v211, v215
v_cvt_pk_bf16_f32 v95, v219, v223
s_add_u32 s61, s58, 3
s_and_b32 s61, s61, 3
s_mul_i32 s61, s61, 917504
s_add_u32 s61, s61, s7
s_add_u32 s62, s61, 458752
buffer_load_dwordx4 v[192:195], v5, s[28:31], s62 offen
s_add_u32 s62, s61, 473088
buffer_load_dwordx4 v[196:199], v5, s[28:31], s62 offen
s_add_u32 s62, s61, 487424
buffer_load_dwordx4 v[200:203], v5, s[28:31], s62 offen
s_add_u32 s62, s61, 501760
buffer_load_dwordx4 v[204:207], v5, s[28:31], s62 offen
s_add_u32 s62, s61, 688128
buffer_load_dwordx4 v[208:211], v5, s[28:31], s62 offen
s_add_u32 s62, s61, 702464
buffer_load_dwordx4 v[212:215], v5, s[28:31], s62 offen
s_add_u32 s62, s61, 716800
buffer_load_dwordx4 v[216:219], v5, s[28:31], s62 offen
s_add_u32 s62, s61, 731136
buffer_load_dwordx4 v[220:223], v5, s[28:31], s62 offen
s_waitcnt vmcnt(16)
v_cvt_f32_i32 v224, v224
v_cvt_f32_i32 v225, v225
v_cvt_f32_i32 v226, v226
v_cvt_f32_i32 v227, v227
v_cvt_f32_i32 v228, v228
v_cvt_f32_i32 v229, v229
v_cvt_f32_i32 v230, v230
v_cvt_f32_i32 v231, v231
v_cvt_f32_i32 v232, v232
v_cvt_f32_i32 v233, v233
v_cvt_f32_i32 v234, v234
v_cvt_f32_i32 v235, v235
v_cvt_f32_i32 v236, v236
v_cvt_f32_i32 v237, v237
v_cvt_f32_i32 v238, v238
v_cvt_f32_i32 v239, v239
v_cvt_f32_i32 v240, v240
v_cvt_f32_i32 v241, v241
v_cvt_f32_i32 v242, v242
v_cvt_f32_i32 v243, v243
v_cvt_f32_i32 v244, v244
v_cvt_f32_i32 v245, v245
v_cvt_f32_i32 v246, v246
v_cvt_f32_i32 v247, v247
v_cvt_f32_i32 v248, v248
v_cvt_f32_i32 v249, v249
v_cvt_f32_i32 v250, v250
v_cvt_f32_i32 v251, v251
v_cvt_f32_i32 v252, v252
v_cvt_f32_i32 v253, v253
v_cvt_f32_i32 v254, v254
v_cvt_f32_i32 v255, v255
.p2align 3
v_pk_fma_f32 v[224:225], v[224:225], v[8:9], v[12:13]
v_pk_fma_f32 v[226:227], v[226:227], v[10:11], v[14:15]
v_pk_fma_f32 v[228:229], v[228:229], v[8:9], v[12:13]
v_pk_fma_f32 v[230:231], v[230:231], v[10:11], v[14:15]
v_pk_fma_f32 v[232:233], v[232:233], v[8:9], v[12:13]
v_pk_fma_f32 v[234:235], v[234:235], v[10:11], v[14:15]
v_pk_fma_f32 v[236:237], v[236:237], v[8:9], v[12:13]
v_pk_fma_f32 v[238:239], v[238:239], v[10:11], v[14:15]
v_pk_fma_f32 v[240:241], v[240:241], v[8:9], v[12:13]
v_pk_fma_f32 v[242:243], v[242:243], v[10:11], v[14:15]
v_pk_fma_f32 v[244:245], v[244:245], v[8:9], v[12:13]
v_pk_fma_f32 v[246:247], v[246:247], v[10:11], v[14:15]
v_pk_fma_f32 v[248:249], v[248:249], v[8:9], v[12:13]
v_pk_fma_f32 v[250:251], v[250:251], v[10:11], v[14:15]
v_pk_fma_f32 v[252:253], v[252:253], v[8:9], v[12:13]
v_pk_fma_f32 v[254:255], v[254:255], v[10:11], v[14:15]
v_cvt_pk_bf16_f32 v96, v224, v228
v_cvt_pk_bf16_f32 v97, v232, v236
v_cvt_pk_bf16_f32 v98, v240, v244
v_cvt_pk_bf16_f32 v99, v248, v252
v_cvt_pk_bf16_f32 v100, v225, v229
v_cvt_pk_bf16_f32 v101, v233, v237
v_cvt_pk_bf16_f32 v102, v241, v245
v_cvt_pk_bf16_f32 v103, v249, v253
v_cvt_pk_bf16_f32 v104, v226, v230
v_cvt_pk_bf16_f32 v105, v234, v238
v_cvt_pk_bf16_f32 v106, v242, v246
v_cvt_pk_bf16_f32 v107, v250, v254
v_cvt_pk_bf16_f32 v108, v227, v231
v_cvt_pk_bf16_f32 v109, v235, v239
v_cvt_pk_bf16_f32 v110, v243, v247
v_cvt_pk_bf16_f32 v111, v251, v255
s_add_u32 m0, s16, 16384
s_add_u32 s62, s14, 458752
buffer_load_dwordx4 v6, s[44:47], s62 offen lds
s_add_u32 m0, s16, 20480
s_add_u32 s62, s14, 573440
buffer_load_dwordx4 v6, s[44:47], s62 offen lds
s_add_u32 m0, s16, 24576
s_add_u32 s62, s14, 688128
buffer_load_dwordx4 v6, s[44:47], s62 offen lds
s_add_u32 m0, s17, 28672
s_add_u32 s62, s15, 802816
buffer_load_dwordx4 v6, s[44:47], s62 offen lds
s_add_u32 m0, s17, 32768
s_add_u32 s62, s15, 917504
buffer_load_dwordx4 v6, s[44:47], s62 offen lds
s_waitcnt vmcnt(13)
v_lshlrev_b32 v8, 16, v156
v_and_b32 v9, 0xffff0000, v156
v_lshlrev_b32 v10, 16, v157
v_and_b32 v11, 0xffff0000, v157
v_lshlrev_b32 v12, 16, v158
v_and_b32 v13, 0xffff0000, v158
v_lshlrev_b32 v14, 16, v159
v_and_b32 v15, 0xffff0000, v159
v_mul_f32 v12, -v12, v8
v_mul_f32 v13, -v13, v9
v_mul_f32 v14, -v14, v10
v_mul_f32 v15, -v15, v11
v_cvt_f32_i32 v160, v160
v_cvt_f32_i32 v161, v161
v_cvt_f32_i32 v162, v162
v_cvt_f32_i32 v163, v163
v_cvt_f32_i32 v164, v164
v_cvt_f32_i32 v165, v165
v_cvt_f32_i32 v166, v166
v_cvt_f32_i32 v167, v167
v_cvt_f32_i32 v168, v168
v_cvt_f32_i32 v169, v169
v_cvt_f32_i32 v170, v170
v_cvt_f32_i32 v171, v171
v_cvt_f32_i32 v172, v172
v_cvt_f32_i32 v173, v173
v_cvt_f32_i32 v174, v174
v_cvt_f32_i32 v175, v175
v_cvt_f32_i32 v176, v176
v_cvt_f32_i32 v177, v177
v_cvt_f32_i32 v178, v178
v_cvt_f32_i32 v179, v179
v_cvt_f32_i32 v180, v180
v_cvt_f32_i32 v181, v181
v_cvt_f32_i32 v182, v182
v_cvt_f32_i32 v183, v183
v_cvt_f32_i32 v184, v184
v_cvt_f32_i32 v185, v185
v_cvt_f32_i32 v186, v186
v_cvt_f32_i32 v187, v187
v_cvt_f32_i32 v188, v188
v_cvt_f32_i32 v189, v189
v_cvt_f32_i32 v190, v190
v_cvt_f32_i32 v191, v191
.p2align 3
v_pk_fma_f32 v[160:161], v[160:161], v[8:9], v[12:13]
v_pk_fma_f32 v[162:163], v[162:163], v[10:11], v[14:15]
v_pk_fma_f32 v[164:165], v[164:165], v[8:9], v[12:13]
v_pk_fma_f32 v[166:167], v[166:167], v[10:11], v[14:15]
v_pk_fma_f32 v[168:169], v[168:169], v[8:9], v[12:13]
v_pk_fma_f32 v[170:171], v[170:171], v[10:11], v[14:15]
v_pk_fma_f32 v[172:173], v[172:173], v[8:9], v[12:13]
v_pk_fma_f32 v[174:175], v[174:175], v[10:11], v[14:15]
v_pk_fma_f32 v[176:177], v[176:177], v[8:9], v[12:13]
v_pk_fma_f32 v[178:179], v[178:179], v[10:11], v[14:15]
v_pk_fma_f32 v[180:181], v[180:181], v[8:9], v[12:13]
v_pk_fma_f32 v[182:183], v[182:183], v[10:11], v[14:15]
v_pk_fma_f32 v[184:185], v[184:185], v[8:9], v[12:13]
v_pk_fma_f32 v[186:187], v[186:187], v[10:11], v[14:15]
v_pk_fma_f32 v[188:189], v[188:189], v[8:9], v[12:13]
v_pk_fma_f32 v[190:191], v[190:191], v[10:11], v[14:15]
v_cvt_pk_bf16_f32 v112, v160, v164
v_cvt_pk_bf16_f32 v113, v168, v172
v_cvt_pk_bf16_f32 v114, v176, v180
v_cvt_pk_bf16_f32 v115, v184, v188
v_cvt_pk_bf16_f32 v116, v161, v165
v_cvt_pk_bf16_f32 v117, v169, v173
v_cvt_pk_bf16_f32 v118, v177, v181
v_cvt_pk_bf16_f32 v119, v185, v189
v_cvt_pk_bf16_f32 v120, v162, v166
v_cvt_pk_bf16_f32 v121, v170, v174
v_cvt_pk_bf16_f32 v122, v178, v182
v_cvt_pk_bf16_f32 v123, v186, v190
v_cvt_pk_bf16_f32 v124, v163, v167
v_cvt_pk_bf16_f32 v125, v171, v175
v_cvt_pk_bf16_f32 v126, v179, v183
v_cvt_pk_bf16_f32 v127, v187, v191
s_add_u32 m0, s17, 36864
s_add_u32 s62, s15, 1032192
buffer_load_dwordx4 v6, s[44:47], s62 offen lds
s_add_u32 m0, s17, 40960
s_add_u32 s62, s15, 1146880
buffer_load_dwordx4 v6, s[44:47], s62 offen lds
s_add_u32 m0, s17, 45056
s_add_u32 s62, s15, 1261568
buffer_load_dwordx4 v6, s[44:47], s62 offen lds
s_add_u32 m0, s17, 49152
s_add_u32 s62, s15, 1376256
buffer_load_dwordx4 v6, s[44:47], s62 offen lds
s_add_u32 m0, s17, 53248
s_add_u32 s62, s15, 1490944
buffer_load_dwordx4 v6, s[44:47], s62 offen lds
s_waitcnt vmcnt(10)
buffer_load_dword v7, v0, s[52:55], s20 offen sc1
v_cvt_f32_i32 v192, v192
v_cvt_f32_i32 v193, v193
v_cvt_f32_i32 v194, v194
v_cvt_f32_i32 v195, v195
v_cvt_f32_i32 v196, v196
v_cvt_f32_i32 v197, v197
v_cvt_f32_i32 v198, v198
v_cvt_f32_i32 v199, v199
v_cvt_f32_i32 v200, v200
v_cvt_f32_i32 v201, v201
v_cvt_f32_i32 v202, v202
v_cvt_f32_i32 v203, v203
v_cvt_f32_i32 v204, v204
v_cvt_f32_i32 v205, v205
v_cvt_f32_i32 v206, v206
v_cvt_f32_i32 v207, v207
v_cvt_f32_i32 v208, v208
v_cvt_f32_i32 v209, v209
v_cvt_f32_i32 v210, v210
v_cvt_f32_i32 v211, v211
v_cvt_f32_i32 v212, v212
v_cvt_f32_i32 v213, v213
v_cvt_f32_i32 v214, v214
v_cvt_f32_i32 v215, v215
v_cvt_f32_i32 v216, v216
v_cvt_f32_i32 v217, v217
v_cvt_f32_i32 v218, v218
v_cvt_f32_i32 v219, v219
v_cvt_f32_i32 v220, v220
v_cvt_f32_i32 v221, v221
v_cvt_f32_i32 v222, v222
v_cvt_f32_i32 v223, v223
.p2align 3
v_pk_fma_f32 v[192:193], v[192:193], v[8:9], v[12:13]
v_pk_fma_f32 v[194:195], v[194:195], v[10:11], v[14:15]
v_pk_fma_f32 v[196:197], v[196:197], v[8:9], v[12:13]
v_pk_fma_f32 v[198:199], v[198:199], v[10:11], v[14:15]
v_pk_fma_f32 v[200:201], v[200:201], v[8:9], v[12:13]
v_pk_fma_f32 v[202:203], v[202:203], v[10:11], v[14:15]
v_pk_fma_f32 v[204:205], v[204:205], v[8:9], v[12:13]
v_pk_fma_f32 v[206:207], v[206:207], v[10:11], v[14:15]
v_pk_fma_f32 v[208:209], v[208:209], v[8:9], v[12:13]
v_pk_fma_f32 v[210:211], v[210:211], v[10:11], v[14:15]
v_pk_fma_f32 v[212:213], v[212:213], v[8:9], v[12:13]
v_pk_fma_f32 v[214:215], v[214:215], v[10:11], v[14:15]
v_pk_fma_f32 v[216:217], v[216:217], v[8:9], v[12:13]
v_pk_fma_f32 v[218:219], v[218:219], v[10:11], v[14:15]
v_pk_fma_f32 v[220:221], v[220:221], v[8:9], v[12:13]
v_pk_fma_f32 v[222:223], v[222:223], v[10:11], v[14:15]
v_cvt_pk_bf16_f32 v128, v192, v196
v_cvt_pk_bf16_f32 v129, v200, v204
v_cvt_pk_bf16_f32 v130, v208, v212
v_cvt_pk_bf16_f32 v131, v216, v220
v_cvt_pk_bf16_f32 v132, v193, v197
v_cvt_pk_bf16_f32 v133, v201, v205
v_cvt_pk_bf16_f32 v134, v209, v213
v_cvt_pk_bf16_f32 v135, v217, v221
v_cvt_pk_bf16_f32 v136, v194, v198
v_cvt_pk_bf16_f32 v137, v202, v206
v_cvt_pk_bf16_f32 v138, v210, v214
v_cvt_pk_bf16_f32 v139, v218, v222
v_cvt_pk_bf16_f32 v140, v195, v199
v_cvt_pk_bf16_f32 v141, v203, v207
v_cvt_pk_bf16_f32 v142, v211, v215
v_cvt_pk_bf16_f32 v143, v219, v223
s_add_u32 s62, s10, 0
s_and_b32 s62, s62, 3
s_lshl_b32 s62, s62, 10
v_add_u32 v8, s62, v2
s_add_u32 s62, s10, 1
s_and_b32 s62, s62, 3
s_lshl_b32 s62, s62, 10
v_add_u32 v9, s62, v2
s_add_u32 s62, s10, 2
s_and_b32 s62, s62, 3
s_lshl_b32 s62, s62, 10
v_add_u32 v10, s62, v2
s_add_u32 s62, s10, 3
s_and_b32 s62, s62, 3
s_lshl_b32 s62, s62, 10
v_add_u32 v11, s62, v2
s_add_u32 s62, s3, 1
s_and_b32 s62, s62, 3
s_mul_i32 s62, s62, 12288
s_add_u32 s62, s62, 114688
v_add_u32 v13, s62, v2
s_add_u32 s62, s3, 2
s_and_b32 s62, s62, 3
s_mul_i32 s62, s62, 12288
s_add_u32 s62, s62, 118784
v_add_u32 v14, s62, v2
s_add_u32 s62, s3, 3
s_and_b32 s62, s62, 3
s_mul_i32 s62, s62, 12288
s_add_u32 s62, s62, 122880
v_add_u32 v15, s62, v2
s_mul_i32 s62, s3, 12288
s_add_u32 s62, s62, 114688
v_add_u32 v12, s62, v2
v_lshlrev_b32 v144, 10, v4
v_lshl_add_u32 v144, v3, 4, v144
s_lshl_b32 s61, s58, 1
s_lshr_b32 s62, s10, 1
s_add_u32 s61, s61, s62
s_mul_i32 s61, s61, 224
s_lshl_b32 s62, s59, 2
s_add_u32 s61, s61, s62
s_lshl_b32 s61, s61, 10
s_and_b32 s62, s10, 1
s_lshl_b32 s62, s62, 8
s_add_u32 s61, s61, s62
s_add_u32 s23, s61, 1048576
s_lshl_b32 s19, s64, 2
s_add_u32 s19, s19, s9
s_lshl_b32 s19, s19, 12
s_add_u32 s19, s19, 3276800
s_mul_i32 s61, s9, 14
s_sub_u32 s61, s59, s61
s_lshl_b32 s61, s61, 1
s_and_b32 s62, s58, 1
s_add_u32 s61, s61, s62
s_lshl_b32 s61, s61, 2
s_add_u32 s21, s61, s19
v_lshrrev_b32 v146, 5, v1
v_lshlrev_b32 v146, 11, v146
v_bfe_u32 v147, v1, 2, 2
v_lshl_add_u32 v146, v147, 8, v146
v_xor_b32 v147, s3, v147
v_lshl_add_u32 v146, v147, 6, v146
v_bfe_u32 v147, v1, 4, 1
v_lshl_add_u32 v146, v147, 5, v146
v_and_b32 v147, 3, v1
v_lshl_add_u32 v146, v147, 3, v146
v_add_u32 v147, 0x10000, v146
s_mov_b32 s63, 100000
s_branch L_poll1E_w
L_poll1E:
buffer_load_dword v7, v0, s[52:55], s20 offen sc1
L_poll1E_w:
s_sub_u32 s63, s63, 1
s_cbranch_scc1 L_poll1E_x
s_waitcnt vmcnt(0)
v_cmp_ne_u32 vcc, s60, v7
s_cbranch_vccnz L_poll1E
L_poll1E_x:
buffer_load_dwordx4 a[116:119], v9, s[52:55], s24 offen sc1
buffer_load_dwordx4 a[132:135], v9, s[52:55], s25 offen sc1
buffer_load_dwordx4 a[148:151], v9, s[52:55], s26 offen sc1
buffer_load_dwordx4 a[164:167], v9, s[52:55], s27 offen sc1
buffer_load_dwordx4 a[180:183], v9, s[52:55], s40 offen sc1
buffer_load_dwordx4 a[196:199], v9, s[52:55], s41 offen sc1
buffer_load_dwordx4 a[212:215], v9, s[52:55], s42 offen sc1
buffer_load_dwordx4 a[228:231], v9, s[52:55], s43 offen sc1
buffer_load_dwordx4 a[120:123], v10, s[52:55], s24 offen sc1
buffer_load_dwordx4 a[136:139], v10, s[52:55], s25 offen sc1
buffer_load_dwordx4 a[152:155], v10, s[52:55], s26 offen sc1
buffer_load_dwordx4 a[168:171], v10, s[52:55], s27 offen sc1
v_mov_b32 v0, 0
v_mov_b32 v7, s60
s_waitcnt vmcnt(11)
v_mfma_f32_16x16x32_bf16 v[160:163], v[16:19], a[116:119], 0
v_mfma_f32_16x16x32_bf16 v[164:167], v[20:23], a[116:119], 0
buffer_load_dwordx4 a[184:187], v10, s[52:55], s40 offen sc1
v_mfma_f32_16x16x32_bf16 v[168:171], v[24:27], a[116:119], 0
v_mfma_f32_16x16x32_bf16 v[172:175], v[28:31], a[116:119], 0
buffer_load_dwordx4 a[200:203], v10, s[52:55], s41 offen sc1
s_waitcnt vmcnt(12)
v_mfma_f32_16x16x32_bf16 v[160:163], v[32:35], a[132:135], v[160:163]
v_mfma_f32_16x16x32_bf16 v[164:167], v[36:39], a[132:135], v[164:167]
buffer_load_dwordx4 a[216:219], v10, s[52:55], s42 offen sc1
v_mfma_f32_16x16x32_bf16 v[168:171], v[40:43], a[132:135], v[168:171]
v_mfma_f32_16x16x32_bf16 v[172:175], v[44:47], a[132:135], v[172:175]
buffer_load_dwordx4 a[232:235], v10, s[52:55], s43 offen sc1
s_waitcnt vmcnt(13)
v_mfma_f32_16x16x32_bf16 v[160:163], v[48:51], a[148:151], v[160:163]
v_mfma_f32_16x16x32_bf16 v[164:167], v[52:55], a[148:151], v[164:167]
buffer_load_dwordx4 a[124:127], v11, s[52:55], s24 offen sc1
v_mfma_f32_16x16x32_bf16 v[168:171], v[56:59], a[148:151], v[168:171]
v_mfma_f32_16x16x32_bf16 v[172:175], v[60:63], a[148:151], v[172:175]
buffer_load_dwordx4 a[140:143], v11, s[52:55], s25 offen sc1
s_waitcnt vmcnt(14)
v_mfma_f32_16x16x32_bf16 v[160:163], v[64:67], a[164:167], v[160:163]
v_mfma_f32_16x16x32_bf16 v[164:167], v[68:71], a[164:167], v[164:167]
buffer_load_dwordx4 a[156:159], v11, s[52:55], s26 offen sc1
v_mfma_f32_16x16x32_bf16 v[168:171], v[72:75], a[164:167], v[168:171]
v_mfma_f32_16x16x32_bf16 v[172:175], v[76:79], a[164:167], v[172:175]
buffer_load_dwordx4 a[172:175], v11, s[52:55], s27 offen sc1
s_waitcnt vmcnt(15)
v_mfma_f32_16x16x32_bf16 v[160:163], v[80:83], a[180:183], v[160:163]
v_mfma_f32_16x16x32_bf16 v[164:167], v[84:87], a[180:183], v[164:167]
buffer_load_dwordx4 a[188:191], v11, s[52:55], s40 offen sc1
v_mfma_f32_16x16x32_bf16 v[168:171], v[88:91], a[180:183], v[168:171]
v_mfma_f32_16x16x32_bf16 v[172:175], v[92:95], a[180:183], v[172:175]
buffer_load_dwordx4 a[204:207], v11, s[52:55], s41 offen sc1
s_waitcnt vmcnt(16)
v_mfma_f32_16x16x32_bf16 v[160:163], v[96:99], a[196:199], v[160:163]
v_mfma_f32_16x16x32_bf16 v[164:167], v[100:103], a[196:199], v[164:167]
buffer_load_dwordx4 a[220:223], v11, s[52:55], s42 offen sc1
v_mfma_f32_16x16x32_bf16 v[168:171], v[104:107], a[196:199], v[168:171]
v_mfma_f32_16x16x32_bf16 v[172:175], v[108:111], a[196:199], v[172:175]
buffer_load_dwordx4 a[236:239], v11, s[52:55], s43 offen sc1
s_waitcnt vmcnt(17)
v_mfma_f32_16x16x32_bf16 v[160:163], v[112:115], a[212:215], v[160:163]
v_mfma_f32_16x16x32_bf16 v[164:167], v[116:119], a[212:215], v[164:167]
buffer_load_dwordx4 a[112:115], v8, s[52:55], s24 offen sc1
v_mfma_f32_16x16x32_bf16 v[168:171], v[120:123], a[212:215], v[168:171]
v_mfma_f32_16x16x32_bf16 v[172:175], v[124:127], a[212:215], v[172:175]
buffer_load_dwordx4 a[128:131], v8, s[52:55], s25 offen sc1
s_waitcnt vmcnt(18)
v_mfma_f32_16x16x32_bf16 v[160:163], v[128:131], a[228:231], v[160:163]
v_mfma_f32_16x16x32_bf16 v[164:167], v[132:135], a[228:231], v[164:167]
buffer_load_dwordx4 a[144:147], v8, s[52:55], s26 offen sc1
v_mfma_f32_16x16x32_bf16 v[168:171], v[136:139], a[228:231], v[168:171]
v_mfma_f32_16x16x32_bf16 v[172:175], v[140:143], a[228:231], v[172:175]
buffer_load_dwordx4 a[160:163], v8, s[52:55], s27 offen sc1
s_waitcnt vmcnt(19)
v_mfma_f32_16x16x32_bf16 v[176:179], v[16:19], a[120:123], 0
v_mfma_f32_16x16x32_bf16 v[180:183], v[20:23], a[120:123], 0
buffer_load_dwordx4 a[176:179], v8, s[52:55], s40 offen sc1
v_mfma_f32_16x16x32_bf16 v[184:187], v[24:27], a[120:123], 0
v_mfma_f32_16x16x32_bf16 v[188:191], v[28:31], a[120:123], 0
buffer_load_dwordx4 a[192:195], v8, s[52:55], s41 offen sc1
s_waitcnt vmcnt(20)
v_mfma_f32_16x16x32_bf16 v[176:179], v[32:35], a[136:139], v[176:179]
v_mfma_f32_16x16x32_bf16 v[180:183], v[36:39], a[136:139], v[180:183]
buffer_load_dwordx4 a[208:211], v8, s[52:55], s42 offen sc1
v_mfma_f32_16x16x32_bf16 v[184:187], v[40:43], a[136:139], v[184:187]
v_mfma_f32_16x16x32_bf16 v[188:191], v[44:47], a[136:139], v[188:191]
buffer_load_dwordx4 a[224:227], v8, s[52:55], s43 offen sc1
s_waitcnt vmcnt(21)
v_mfma_f32_16x16x32_bf16 v[176:179], v[48:51], a[152:155], v[176:179]
ds_write_b128 v13, v[160:163] offset:0
v_mfma_f32_16x16x32_bf16 v[180:183], v[52:55], a[152:155], v[180:183]
ds_write_b128 v13, v[164:167] offset:1024
v_mfma_f32_16x16x32_bf16 v[184:187], v[56:59], a[152:155], v[184:187]
ds_write_b128 v13, v[168:171] offset:2048
v_mfma_f32_16x16x32_bf16 v[188:191], v[60:63], a[152:155], v[188:191]
ds_write_b128 v13, v[172:175] offset:3072
s_waitcnt vmcnt(20)
v_mfma_f32_16x16x32_bf16 v[176:179], v[64:67], a[168:171], v[176:179]
v_mfma_f32_16x16x32_bf16 v[180:183], v[68:71], a[168:171], v[180:183]
v_mfma_f32_16x16x32_bf16 v[184:187], v[72:75], a[168:171], v[184:187]
v_mfma_f32_16x16x32_bf16 v[188:191], v[76:79], a[168:171], v[188:191]
s_waitcnt vmcnt(19)
v_mfma_f32_16x16x32_bf16 v[176:179], v[80:83], a[184:187], v[176:179]
v_mfma_f32_16x16x32_bf16 v[180:183], v[84:87], a[184:187], v[180:183]
v_mfma_f32_16x16x32_bf16 v[184:187], v[88:91], a[184:187], v[184:187]
v_mfma_f32_16x16x32_bf16 v[188:191], v[92:95], a[184:187], v[188:191]
s_waitcnt vmcnt(18)
v_mfma_f32_16x16x32_bf16 v[176:179], v[96:99], a[200:203], v[176:179]
v_mfma_f32_16x16x32_bf16 v[180:183], v[100:103], a[200:203], v[180:183]
v_mfma_f32_16x16x32_bf16 v[184:187], v[104:107], a[200:203], v[184:187]
v_mfma_f32_16x16x32_bf16 v[188:191], v[108:111], a[200:203], v[188:191]
s_waitcnt vmcnt(17)
v_mfma_f32_16x16x32_bf16 v[176:179], v[112:115], a[216:219], v[176:179]
v_mfma_f32_16x16x32_bf16 v[180:183], v[116:119], a[216:219], v[180:183]
v_mfma_f32_16x16x32_bf16 v[184:187], v[120:123], a[216:219], v[184:187]
v_mfma_f32_16x16x32_bf16 v[188:191], v[124:127], a[216:219], v[188:191]
s_waitcnt vmcnt(16)
v_mfma_f32_16x16x32_bf16 v[176:179], v[128:131], a[232:235], v[176:179]
v_mfma_f32_16x16x32_bf16 v[180:183], v[132:135], a[232:235], v[180:183]
v_mfma_f32_16x16x32_bf16 v[184:187], v[136:139], a[232:235], v[184:187]
v_mfma_f32_16x16x32_bf16 v[188:191], v[140:143], a[232:235], v[188:191]
s_waitcnt vmcnt(15)
v_mfma_f32_16x16x32_bf16 v[192:195], v[16:19], a[124:127], 0
v_mfma_f32_16x16x32_bf16 v[196:199], v[20:23], a[124:127], 0
s_add_u32 m0, s16, 57344
s_add_u32 s62, s14, 1605632
buffer_load_dwordx4 v6, s[44:47], s62 offen lds
v_mfma_f32_16x16x32_bf16 v[200:203], v[24:27], a[124:127], 0
v_mfma_f32_16x16x32_bf16 v[204:207], v[28:31], a[124:127], 0
s_waitcnt vmcnt(15)
v_mfma_f32_16x16x32_bf16 v[192:195], v[32:35], a[140:143], v[192:195]
v_mfma_f32_16x16x32_bf16 v[196:199], v[36:39], a[140:143], v[196:199]
s_add_u32 m0, s16, 61440
s_add_u32 s62, s14, 1720320
buffer_load_dwordx4 v6, s[44:47], s62 offen lds
v_mfma_f32_16x16x32_bf16 v[200:203], v[40:43], a[140:143], v[200:203]
v_mfma_f32_16x16x32_bf16 v[204:207], v[44:47], a[140:143], v[204:207]
s_waitcnt vmcnt(15)
v_mfma_f32_16x16x32_bf16 v[192:195], v[48:51], a[156:159], v[192:195]
ds_write_b128 v14, v[176:179] offset:0
v_mfma_f32_16x16x32_bf16 v[196:199], v[52:55], a[156:159], v[196:199]
ds_write_b128 v14, v[180:183] offset:1024
s_add_u32 m0, s16, 65536
s_add_u32 s62, s14, 1835008
buffer_load_dwordx4 v6, s[44:47], s62 offen lds
v_mfma_f32_16x16x32_bf16 v[200:203], v[56:59], a[156:159], v[200:203]
ds_write_b128 v14, v[184:187] offset:2048
v_mfma_f32_16x16x32_bf16 v[204:207], v[60:63], a[156:159], v[204:207]
ds_write_b128 v14, v[188:191] offset:3072
s_waitcnt vmcnt(15)
v_mfma_f32_16x16x32_bf16 v[192:195], v[64:67], a[172:175], v[192:195]
v_mfma_f32_16x16x32_bf16 v[196:199], v[68:71], a[172:175], v[196:199]
s_add_u32 m0, s16, 69632
s_add_u32 s62, s14, 1949696
buffer_load_dwordx4 v6, s[44:47], s62 offen lds
v_mfma_f32_16x16x32_bf16 v[200:203], v[72:75], a[172:175], v[200:203]
v_mfma_f32_16x16x32_bf16 v[204:207], v[76:79], a[172:175], v[204:207]
s_waitcnt vmcnt(15)
v_mfma_f32_16x16x32_bf16 v[192:195], v[80:83], a[188:191], v[192:195]
v_mfma_f32_16x16x32_bf16 v[196:199], v[84:87], a[188:191], v[196:199]
s_add_u32 m0, s16, 73728
s_add_u32 s62, s14, 2064384
buffer_load_dwordx4 v6, s[44:47], s62 offen lds
v_mfma_f32_16x16x32_bf16 v[200:203], v[88:91], a[188:191], v[200:203]
v_mfma_f32_16x16x32_bf16 v[204:207], v[92:95], a[188:191], v[204:207]
s_waitcnt vmcnt(15)
v_mfma_f32_16x16x32_bf16 v[192:195], v[96:99], a[204:207], v[192:195]
v_mfma_f32_16x16x32_bf16 v[196:199], v[100:103], a[204:207], v[196:199]
s_add_u32 m0, s16, 77824
s_add_u32 s62, s14, 2179072
buffer_load_dwordx4 v6, s[44:47], s62 offen lds
v_mfma_f32_16x16x32_bf16 v[200:203], v[104:107], a[204:207], v[200:203]
v_mfma_f32_16x16x32_bf16 v[204:207], v[108:111], a[204:207], v[204:207]
s_waitcnt vmcnt(15)
v_mfma_f32_16x16x32_bf16 v[192:195], v[112:115], a[220:223], v[192:195]
v_mfma_f32_16x16x32_bf16 v[196:199], v[116:119], a[220:223], v[196:199]
s_add_u32 m0, s16, 81920
s_add_u32 s62, s14, 2293760
buffer_load_dwordx4 v6, s[44:47], s62 offen lds
v_mfma_f32_16x16x32_bf16 v[200:203], v[120:123], a[220:223], v[200:203]
v_mfma_f32_16x16x32_bf16 v[204:207], v[124:127], a[220:223], v[204:207]
s_waitcnt vmcnt(15)
v_mfma_f32_16x16x32_bf16 v[192:195], v[128:131], a[236:239], v[192:195]
v_mfma_f32_16x16x32_bf16 v[196:199], v[132:135], a[236:239], v[196:199]
v_mfma_f32_16x16x32_bf16 v[200:203], v[136:139], a[236:239], v[200:203]
v_mfma_f32_16x16x32_bf16 v[204:207], v[140:143], a[236:239], v[204:207]
s_waitcnt vmcnt(14)
v_mfma_f32_16x16x32_bf16 v[208:211], v[16:19], a[112:115], 0
v_mfma_f32_16x16x32_bf16 v[212:215], v[20:23], a[112:115], 0
v_mfma_f32_16x16x32_bf16 v[216:219], v[24:27], a[112:115], 0
v_mfma_f32_16x16x32_bf16 v[220:223], v[28:31], a[112:115], 0
s_waitcnt vmcnt(13)
v_mfma_f32_16x16x32_bf16 v[208:211], v[32:35], a[128:131], v[208:211]
v_mfma_f32_16x16x32_bf16 v[212:215], v[36:39], a[128:131], v[212:215]
v_mfma_f32_16x16x32_bf16 v[216:219], v[40:43], a[128:131], v[216:219]
v_mfma_f32_16x16x32_bf16 v[220:223], v[44:47], a[128:131], v[220:223]
s_waitcnt vmcnt(12)
v_mfma_f32_16x16x32_bf16 v[208:211], v[48:51], a[144:147], v[208:211]
ds_write_b128 v15, v[192:195] offset:0
v_mfma_f32_16x16x32_bf16 v[212:215], v[52:55], a[144:147], v[212:215]
ds_write_b128 v15, v[196:199] offset:1024
v_mfma_f32_16x16x32_bf16 v[216:219], v[56:59], a[144:147], v[216:219]
ds_write_b128 v15, v[200:203] offset:2048
v_mfma_f32_16x16x32_bf16 v[220:223], v[60:63], a[144:147], v[220:223]
ds_write_b128 v15, v[204:207] offset:3072
s_waitcnt vmcnt(11)
v_mfma_f32_16x16x32_bf16 v[208:211], v[64:67], a[160:163], v[208:211]
v_mfma_f32_16x16x32_bf16 v[212:215], v[68:71], a[160:163], v[212:215]
v_mfma_f32_16x16x32_bf16 v[216:219], v[72:75], a[160:163], v[216:219]
v_mfma_f32_16x16x32_bf16 v[220:223], v[76:79], a[160:163], v[220:223]
s_waitcnt vmcnt(10)
s_waitcnt lgkmcnt(0)
s_barrier
v_mfma_f32_16x16x32_bf16 v[208:211], v[80:83], a[176:179], v[208:211]
ds_read_b128 v[160:163], v12 offset:0
v_mfma_f32_16x16x32_bf16 v[212:215], v[84:87], a[176:179], v[212:215]
ds_read_b128 v[164:167], v12 offset:1024
v_mfma_f32_16x16x32_bf16 v[216:219], v[88:91], a[176:179], v[216:219]
ds_read_b128 v[168:171], v12 offset:2048
v_mfma_f32_16x16x32_bf16 v[220:223], v[92:95], a[176:179], v[220:223]
ds_read_b128 v[172:175], v12 offset:3072
s_waitcnt vmcnt(9)
v_mfma_f32_16x16x32_bf16 v[208:211], v[96:99], a[192:195], v[208:211]
ds_read_b128 v[176:179], v12 offset:4096
v_mfma_f32_16x16x32_bf16 v[212:215], v[100:103], a[192:195], v[212:215]
ds_read_b128 v[180:183], v12 offset:5120
v_mfma_f32_16x16x32_bf16 v[216:219], v[104:107], a[192:195], v[216:219]
ds_read_b128 v[184:187], v12 offset:6144
v_mfma_f32_16x16x32_bf16 v[220:223], v[108:111], a[192:195], v[220:223]
ds_read_b128 v[188:191], v12 offset:7168
s_waitcnt vmcnt(8)
v_mfma_f32_16x16x32_bf16 v[208:211], v[112:115], a[208:211], v[208:211]
ds_read_b128 v[192:195], v12 offset:8192
v_mfma_f32_16x16x32_bf16 v[212:215], v[116:119], a[208:211], v[212:215]
ds_read_b128 v[196:199], v12 offset:9216
v_mfma_f32_16x16x32_bf16 v[216:219], v[120:123], a[208:211], v[216:219]
ds_read_b128 v[200:203], v12 offset:10240
v_mfma_f32_16x16x32_bf16 v[220:223], v[124:127], a[208:211], v[220:223]
ds_read_b128 v[204:207], v12 offset:11264
s_waitcnt vmcnt(7)
v_mfma_f32_16x16x32_bf16 v[208:211], v[128:131], a[224:227], v[208:211]
v_mfma_f32_16x16x32_bf16 v[212:215], v[132:135], a[224:227], v[212:215]
v_mfma_f32_16x16x32_bf16 v[216:219], v[136:139], a[224:227], v[216:219]
v_mfma_f32_16x16x32_bf16 v[220:223], v[140:143], a[224:227], v[220:223]
s_waitcnt lgkmcnt(0)
.p2align 3
v_pk_add_f32 v[160:161], v[160:161], v[176:177]
v_pk_add_f32 v[162:163], v[162:163], v[178:179]
v_pk_add_f32 v[164:165], v[164:165], v[180:181]
v_pk_add_f32 v[166:167], v[166:167], v[182:183]
v_pk_add_f32 v[168:169], v[168:169], v[184:185]
v_pk_add_f32 v[170:171], v[170:171], v[186:187]
v_pk_add_f32 v[172:173], v[172:173], v[188:189]
v_pk_add_f32 v[174:175], v[174:175], v[190:191]
v_pk_add_f32 v[160:161], v[160:161], v[192:193]
v_pk_add_f32 v[162:163], v[162:163], v[194:195]
v_pk_add_f32 v[164:165], v[164:165], v[196:197]
v_pk_add_f32 v[166:167], v[166:167], v[198:199]
v_pk_add_f32 v[168:169], v[168:169], v[200:201]
v_pk_add_f32 v[170:171], v[170:171], v[202:203]
v_pk_add_f32 v[172:173], v[172:173], v[204:205]
v_pk_add_f32 v[174:175], v[174:175], v[206:207]
v_pk_add_f32 v[160:161], v[160:161], v[208:209]
v_pk_add_f32 v[162:163], v[162:163], v[210:211]
v_pk_add_f32 v[164:165], v[164:165], v[212:213]
v_pk_add_f32 v[166:167], v[166:167], v[214:215]
v_pk_add_f32 v[168:169], v[168:169], v[216:217]
v_pk_add_f32 v[170:171], v[170:171], v[218:219]
v_pk_add_f32 v[172:173], v[172:173], v[220:221]
v_pk_add_f32 v[174:175], v[174:175], v[222:223]
v_cvt_pk_bf16_f32 v224, v160, v164
v_cvt_pk_bf16_f32 v225, v168, v172
v_cvt_pk_bf16_f32 v226, v161, v165
v_cvt_pk_bf16_f32 v227, v169, v173
v_cvt_pk_bf16_f32 v228, v162, v166
v_cvt_pk_bf16_f32 v229, v170, v174
v_cvt_pk_bf16_f32 v230, v163, v167
v_cvt_pk_bf16_f32 v231, v171, v175
buffer_store_dwordx4 v[224:227], v144, s[52:55], s23 offen sc1
buffer_store_dwordx4 v[228:231], v144, s[52:55], s23 offen offset:512 sc1
s_waitcnt vmcnt(0)
s_barrier
s_cmp_lg_u32 s3, 0
s_cbranch_scc1 L_f2doneE
v_lshlrev_b32 v8, 15, v1
s_mov_b64 exec, 3
buffer_store_dword v7, v8, s[52:55], s21 offen sc1
s_mov_b64 exec, -1
L_f2doneE:
s_add_u32 m0, s17, 86016
s_add_u32 s62, s15, 2408448
buffer_load_dwordx4 v6, s[44:47], s62 offen lds
s_add_u32 m0, s17, 90112
s_add_u32 s62, s15, 2523136
buffer_load_dwordx4 v6, s[44:47], s62 offen lds
s_add_u32 m0, s17, 94208
s_add_u32 s62, s15, 2637824
buffer_load_dwordx4 v6, s[44:47], s62 offen lds
s_add_u32 m0, s17, 98304
s_add_u32 s62, s15, 2752512
buffer_load_dwordx4 v6, s[44:47], s62 offen lds
s_add_u32 m0, s17, 102400
s_add_u32 s62, s15, 2867200
buffer_load_dwordx4 v6, s[44:47], s62 offen lds
s_add_u32 m0, s17, 106496
s_add_u32 s62, s15, 2981888
buffer_load_dwordx4 v6, s[44:47], s62 offen lds
s_add_u32 m0, s17, 110592
s_add_u32 s62, s15, 3096576
buffer_load_dwordx4 v6, s[44:47], s62 offen lds
ds_read_b64_tr_b16 a[0:1], v146 offset:0
ds_read_b64_tr_b16 a[2:3], v146 offset:1024
ds_read_b64_tr_b16 a[4:5], v146 offset:4096
ds_read_b64_tr_b16 a[6:7], v146 offset:5120
ds_read_b64_tr_b16 a[8:9], v146 offset:8192
ds_read_b64_tr_b16 a[10:11], v146 offset:9216
ds_read_b64_tr_b16 a[12:13], v146 offset:12288
ds_read_b64_tr_b16 a[14:15], v146 offset:13312
ds_read_b64_tr_b16 a[16:17], v146 offset:16384
ds_read_b64_tr_b16 a[18:19], v146 offset:17408
ds_read_b64_tr_b16 a[20:21], v146 offset:20480
ds_read_b64_tr_b16 a[22:23], v146 offset:21504
ds_read_b64_tr_b16 a[24:25], v146 offset:24576
ds_read_b64_tr_b16 a[26:27], v146 offset:25600
ds_read_b64_tr_b16 a[28:29], v146 offset:28672
ds_read_b64_tr_b16 a[30:31], v146 offset:29696
ds_read_b64_tr_b16 a[32:33], v146 offset:32768
ds_read_b64_tr_b16 a[34:35], v146 offset:33792
ds_read_b64_tr_b16 a[36:37], v146 offset:36864
ds_read_b64_tr_b16 a[38:39], v146 offset:37888
ds_read_b64_tr_b16 a[40:41], v146 offset:40960
ds_read_b64_tr_b16 a[42:43], v146 offset:41984
ds_read_b64_tr_b16 a[44:45], v146 offset:45056
ds_read_b64_tr_b16 a[46:47], v146 offset:46080
ds_read_b64_tr_b16 a[48:49], v146 offset:49152
ds_read_b64_tr_b16 a[50:51], v146 offset:50176
ds_read_b64_tr_b16 a[52:53], v146 offset:53248
ds_read_b64_tr_b16 a[54:55], v146 offset:54272
s_waitcnt lgkmcnt(0)
s_barrier
s_add_u32 m0, s16, 0
s_add_u32 s62, s14, 3211264
buffer_load_dwordx4 v6, s[44:47], s62 offen lds
s_add_u32 m0, s16, 4096
s_add_u32 s62, s14, 3325952
buffer_load_dwordx4 v6, s[44:47], s62 offen lds
s_add_u32 m0, s16, 8192
s_add_u32 s62, s14, 3440640
buffer_load_dwordx4 v6, s[44:47], s62 offen lds
s_add_u32 m0, s16, 12288
s_add_u32 s62, s14, 3555328
buffer_load_dwordx4 v6, s[44:47], s62 offen lds
s_add_u32 m0, s16, 16384
s_add_u32 s62, s14, 3670016
buffer_load_dwordx4 v6, s[44:47], s62 offen lds
s_add_u32 m0, s16, 20480
s_add_u32 s62, s14, 3784704
buffer_load_dwordx4 v6, s[44:47], s62 offen lds
s_add_u32 m0, s16, 24576
s_add_u32 s62, s14, 3899392
buffer_load_dwordx4 v6, s[44:47], s62 offen lds
s_add_u32 m0, s17, 28672
s_add_u32 s62, s15, 4014080
buffer_load_dwordx4 v6, s[44:47], s62 offen lds
s_add_u32 m0, s17, 32768
s_add_u32 s62, s15, 4128768
buffer_load_dwordx4 v6, s[44:47], s62 offen lds
s_add_u32 m0, s17, 36864
s_add_u32 s62, s15, 4243456
buffer_load_dwordx4 v6, s[44:47], s62 offen lds
s_add_u32 m0, s17, 40960
s_add_u32 s62, s15, 4358144
buffer_load_dwordx4 v6, s[44:47], s62 offen lds
s_add_u32 m0, s17, 45056
s_add_u32 s62, s15, 4472832
buffer_load_dwordx4 v6, s[44:47], s62 offen lds
s_add_u32 m0, s17, 49152
s_add_u32 s62, s15, 4587520
buffer_load_dwordx4 v6, s[44:47], s62 offen lds
s_add_u32 m0, s17, 53248
s_add_u32 s62, s15, 4702208
buffer_load_dwordx4 v6, s[44:47], s62 offen lds
s_waitcnt vmcnt(14)
s_barrier
ds_read_b64_tr_b16 a[56:57], v146 offset:57344
ds_read_b64_tr_b16 a[58:59], v146 offset:58368
ds_read_b64_tr_b16 a[60:61], v146 offset:61440
ds_read_b64_tr_b16 a[62:63], v146 offset:62464
ds_read_b64_tr_b16 a[64:65], v147 offset:0
ds_read_b64_tr_b16 a[66:67], v147 offset:1024
ds_read_b64_tr_b16 a[68:69], v147 offset:4096
ds_read_b64_tr_b16 a[70:71], v147 offset:5120
ds_read_b64_tr_b16 a[72:73], v147 offset:8192
ds_read_b64_tr_b16 a[74:75], v147 offset:9216
ds_read_b64_tr_b16 a[76:77], v147 offset:12288
ds_read_b64_tr_b16 a[78:79], v147 offset:13312
ds_read_b64_tr_b16 a[80:81], v147 offset:16384
ds_read_b64_tr_b16 a[82:83], v147 offset:17408
ds_read_b64_tr_b16 a[84:85], v147 offset:20480
ds_read_b64_tr_b16 a[86:87], v147 offset:21504
ds_read_b64_tr_b16 a[88:89], v147 offset:24576
ds_read_b64_tr_b16 a[90:91], v147 offset:25600
ds_read_b64_tr_b16 a[92:93], v147 offset:28672
ds_read_b64_tr_b16 a[94:95], v147 offset:29696
ds_read_b64_tr_b16 a[96:97], v147 offset:32768
ds_read_b64_tr_b16 a[98:99], v147 offset:33792
ds_read_b64_tr_b16 a[100:101], v147 offset:36864
ds_read_b64_tr_b16 a[102:103], v147 offset:37888
ds_read_b64_tr_b16 a[104:105], v147 offset:40960
ds_read_b64_tr_b16 a[106:107], v147 offset:41984
ds_read_b64_tr_b16 a[108:109], v147 offset:45056
ds_read_b64_tr_b16 a[110:111], v147 offset:46080
s_add_u32 s10, s9, s11
s_and_b32 s10, s10, 3
s_add_u32 s61, s10, 1
s_and_b32 s61, s61, 3
s_lshl_b32 s62, s64, 2
s_add_u32 s61, s61, s62
s_mul_i32 s61, s61, 224
s_mul_i32 s62, s9, 56
s_add_u32 s61, s61, s62
s_add_u32 s61, s61, s3
s_lshl_b32 s61, s61, 10
s_add_u32 s4, s61, 1048576
s_add_u32 s61, s10, 2
s_and_b32 s61, s61, 3
s_lshl_b32 s62, s64, 2
s_add_u32 s61, s61, s62
s_mul_i32 s61, s61, 224
s_mul_i32 s62, s9, 56
s_add_u32 s61, s61, s62
s_add_u32 s61, s61, s3
s_lshl_b32 s61, s61, 10
s_add_u32 s5, s61, 1048576
s_add_u32 s61, s10, 3
s_and_b32 s61, s61, 3
s_lshl_b32 s62, s64, 2
s_add_u32 s61, s61, s62
s_mul_i32 s61, s61, 224
s_mul_i32 s62, s9, 56
s_add_u32 s61, s61, s62
s_add_u32 s61, s61, s3
s_lshl_b32 s61, s61, 10
s_add_u32 s7, s61, 1048576
s_add_u32 s61, s10, 4
s_and_b32 s61, s61, 3
s_lshl_b32 s62, s64, 2
s_add_u32 s61, s61, s62
s_mul_i32 s61, s61, 224
s_mul_i32 s62, s9, 56
s_add_u32 s61, s61, s62
s_add_u32 s61, s61, s3
s_lshl_b32 s61, s61, 10
s_add_u32 s8, s61, 1048576
v_add_u32 v13, 0x10000, v2
v_add_u32 v15, 0x20000, v2
s_lshl_b32 s20, s65, 18
s_lshl_b32 s61, s9, 16
s_add_u32 s20, s20, s61
s_lshl_b32 s61, s3, 12
s_add_u32 s20, s20, s61
s_add_u32 s20, s20, 16777216
v_min_u32 v12, 27, v1
v_lshlrev_b32 v12, 2, v12
v_and_b32 v9, 31, v1
v_mul_u32_u24 v9, 7168, v9
v_lshrrev_b32 v10, 5, v1
v_lshl_add_u32 v9, v10, 4, v9
s_lshl_b32 s61, s64, 2
s_add_u32 s61, s61, s10
s_mul_i32 s61, s61, 229376
s_lshl_b32 s62, s11, 8
s_add_u32 s61, s61, s62
s_lshl_b32 s62, s3, 6
s_add_u32 s23, s61, s62
v_and_b32 v8, 3, v1
v_mul_u32_u24 v8, 0x14000, v8
s_lshl_b32 s21, s65, 18
s_add_u32 s21, s21, 16777216
s_add_u32 s61, s9, 3
s_and_b32 s61, s61, 3
s_lshl_b32 s61, s61, 14
s_add_u32 s24, s61, s20
s_add_u32 s61, s9, 2
s_and_b32 s61, s61, 3
s_lshl_b32 s61, s61, 14
s_add_u32 s25, s61, s20
s_add_u32 s61, s9, 1
s_and_b32 s61, s61, 3
s_lshl_b32 s61, s61, 14
s_add_u32 s26, s61, s20
s_waitcnt lgkmcnt(0)
s_and_b32 s61, s56, 1
s_lshl_b32 s61, s61, 15
s_add_u32 s19, s19, s61
s_cmp_lg_u32 s3, 3
s_cbranch_scc1 L_poll2_x
s_mov_b32 s63, 100000
L_poll2:
buffer_load_dword v14, v12, s[52:55], s19 offen sc1
L_poll2_w:
s_sub_u32 s63, s63, 1
s_cbranch_scc1 L_poll2_x
s_waitcnt vmcnt(0)
v_cmp_ne_u32 vcc, s60, v14
s_cbranch_vccnz L_poll2
L_poll2_x:
s_barrier
v_mul_u32_u24 v12, 37, v1
v_add_u32 v12, s60, v12
v_and_b32 v12, 0xff, v12
s_mov_b32 s27, 0xffffff00
s_add_u32 m0, s18, 114688
s_add_u32 s62, s4, 0
buffer_load_dwordx4 v2, s[52:55], s62 offen sc1 lds
s_add_u32 m0, s18, 118784
s_add_u32 s62, s5, 0
buffer_load_dwordx4 v2, s[52:55], s62 offen sc1 lds
s_add_u32 m0, s18, 122880
s_add_u32 s62, s7, 0
buffer_load_dwordx4 v2, s[52:55], s62 offen sc1 lds
s_add_u32 m0, s18, 126976
s_add_u32 s62, s4, 4096
buffer_load_dwordx4 v2, s[52:55], s62 offen sc1 lds
s_add_u32 m0, s18, 131072
s_add_u32 s62, s5, 4096
buffer_load_dwordx4 v2, s[52:55], s62 offen sc1 lds
s_add_u32 m0, s18, 135168
s_add_u32 s62, s7, 4096
buffer_load_dwordx4 v2, s[52:55], s62 offen sc1 lds
s_waitcnt vmcnt(4)
s_barrier
ds_read_b128 v[96:99], v13 offset:49152
ds_read_b128 v[100:103], v13 offset:50176
ds_read_b128 v[104:107], v13 offset:51200
ds_read_b128 v[108:111], v13 offset:52224
ds_read_b128 v[112:115], v13 offset:53248
s_waitcnt lgkmcnt(4)
v_mfma_f32_32x32x16_bf16 v[16:31], a[0:3], v[96:99], 0
s_add_u32 m0, s18, 139264
s_add_u32 s62, s4, 8192
buffer_load_dwordx4 v2, s[52:55], s62 offen sc1 lds
ds_read_b64_tr_b16 a[112:113], v146 offset:0
ds_read_b64_tr_b16 a[114:115], v146 offset:1024
ds_read_b128 v[116:119], v13 offset:54272
s_waitcnt lgkmcnt(6)
v_mfma_f32_32x32x16_bf16 v[16:31], a[4:7], v[100:103], v[16:31]
s_add_u32 m0, s18, 143360
s_add_u32 s62, s5, 8192
buffer_load_dwordx4 v2, s[52:55], s62 offen sc1 lds
ds_read_b64_tr_b16 a[116:117], v146 offset:4096
ds_read_b64_tr_b16 a[118:119], v146 offset:5120
ds_read_b128 v[120:123], v13 offset:55296
s_waitcnt lgkmcnt(8)
v_mfma_f32_32x32x16_bf16 v[16:31], a[8:11], v[104:107], v[16:31]
s_add_u32 m0, s18, 147456
s_add_u32 s62, s7, 8192
buffer_load_dwordx4 v2, s[52:55], s62 offen sc1 lds
ds_read_b64_tr_b16 a[120:121], v146 offset:8192
ds_read_b64_tr_b16 a[122:123], v146 offset:9216
ds_read_b128 v[124:127], v13 offset:56320
s_waitcnt lgkmcnt(10)
v_mfma_f32_32x32x16_bf16 v[16:31], a[12:15], v[108:111], v[16:31]
s_add_u32 m0, s18, 151552
s_add_u32 s62, s4, 12288
buffer_load_dwordx4 v2, s[52:55], s62 offen sc1 lds
ds_read_b64_tr_b16 a[124:125], v146 offset:12288
ds_read_b64_tr_b16 a[126:127], v146 offset:13312
s_waitcnt vmcnt(6)
s_barrier
ds_read_b128 v[96:99], v13 offset:57344
s_waitcnt lgkmcnt(12)
v_mfma_f32_32x32x16_bf16 v[32:47], a[0:3], v[112:115], 0
s_add_u32 m0, s18, 155648
s_add_u32 s62, s5, 12288
buffer_load_dwordx4 v2, s[52:55], s62 offen sc1 lds
ds_read_b64_tr_b16 a[128:129], v146 offset:16384
ds_read_b64_tr_b16 a[130:131], v146 offset:17408
ds_read_b128 v[100:103], v13 offset:58368
s_waitcnt lgkmcnt(12)
v_mfma_f32_32x32x16_bf16 v[32:47], a[4:7], v[116:119], v[32:47]
s_add_u32 m0, s18, 159744
s_add_u32 s62, s7, 12288
buffer_load_dwordx4 v2, s[52:55], s62 offen sc1 lds
ds_read_b64_tr_b16 a[132:133], v146 offset:20480
ds_read_b64_tr_b16 a[134:135], v146 offset:21504
ds_read_b128 v[104:107], v13 offset:59392
s_waitcnt lgkmcnt(12)
v_mfma_f32_32x32x16_bf16 v[32:47], a[8:11], v[120:123], v[32:47]
s_add_u32 m0, s18, 114688
s_add_u32 s62, s4, 16384
buffer_load_dwordx4 v2, s[52:55], s62 offen sc1 lds
ds_read_b64_tr_b16 a[136:137], v146 offset:24576
ds_read_b64_tr_b16 a[138:139], v146 offset:25600
ds_read_b128 v[108:111], v13 offset:60416
s_waitcnt lgkmcnt(12)
v_mfma_f32_32x32x16_bf16 v[32:47], a[12:15], v[124:127], v[32:47]
ds_read_b64_tr_b16 a[140:141], v146 offset:28672
ds_read_b64_tr_b16 a[142:143], v146 offset:29696
ds_read_b128 v[112:115], v13 offset:61440
s_waitcnt lgkmcnt(12)
v_mfma_f32_32x32x16_bf16 v[48:63], a[0:3], v[96:99], 0
s_add_u32 m0, s16, 57344
s_add_u32 s62, s14, 4816896
buffer_load_dwordx4 v6, s[44:47], s62 offen lds
ds_read_b64_tr_b16 a[144:145], v146 offset:32768
ds_read_b64_tr_b16 a[146:147], v146 offset:33792
ds_read_b128 v[116:119], v13 offset:62464
s_waitcnt lgkmcnt(12)
v_mfma_f32_32x32x16_bf16 v[48:63], a[4:7], v[100:103], v[48:63]
ds_read_b64_tr_b16 a[148:149], v146 offset:36864
ds_read_b64_tr_b16 a[150:151], v146 offset:37888
ds_read_b128 v[120:123], v13 offset:63488
s_waitcnt lgkmcnt(12)
v_mfma_f32_32x32x16_bf16 v[48:63], a[8:11], v[104:107], v[48:63]
ds_read_b64_tr_b16 a[152:153], v146 offset:40960
ds_read_b64_tr_b16 a[154:155], v146 offset:41984
ds_read_b128 v[124:127], v13 offset:64512
s_waitcnt lgkmcnt(12)
v_mfma_f32_32x32x16_bf16 v[48:63], a[12:15], v[108:111], v[48:63]
ds_read_b64_tr_b16 a[156:157], v146 offset:45056
ds_read_b64_tr_b16 a[158:159], v146 offset:46080
s_waitcnt vmcnt(8)
s_barrier
ds_read_b128 v[96:99], v15 offset:0
s_waitcnt lgkmcnt(12)
v_mfma_f32_32x32x16_bf16 v[16:31], a[16:19], v[112:115], v[16:31]
s_add_u32 m0, s16, 61440
s_add_u32 s62, s14, 4931584
buffer_load_dwordx4 v6, s[44:47], s62 offen lds
ds_read_b64_tr_b16 a[160:161], v146 offset:49152
ds_read_b64_tr_b16 a[162:163], v146 offset:50176
ds_read_b128 v[100:103], v15 offset:1024
s_waitcnt lgkmcnt(12)
v_mfma_f32_32x32x16_bf16 v[16:31], a[20:23], v[116:119], v[16:31]
s_add_u32 m0, s18, 118784
s_add_u32 s62, s5, 16384
buffer_load_dwordx4 v2, s[52:55], s62 offen sc1 lds
ds_read_b64_tr_b16 a[164:165], v146 offset:53248
ds_read_b64_tr_b16 a[166:167], v146 offset:54272
ds_read_b128 v[104:107], v15 offset:2048
s_waitcnt lgkmcnt(12)
v_mfma_f32_32x32x16_bf16 v[16:31], a[24:27], v[120:123], v[16:31]
s_add_u32 m0, s18, 122880
s_add_u32 s62, s7, 16384
buffer_load_dwordx4 v2, s[52:55], s62 offen sc1 lds
ds_read_b128 v[108:111], v15 offset:3072
s_waitcnt lgkmcnt(10)
v_mfma_f32_32x32x16_bf16 v[16:31], a[28:31], v[124:127], v[16:31]
ds_read_b128 v[112:115], v15 offset:4096
s_waitcnt lgkmcnt(8)
v_mfma_f32_32x32x16_bf16 v[32:47], a[16:19], v[96:99], v[32:47]
s_add_u32 m0, s16, 65536
s_add_u32 s62, s14, 5046272
buffer_load_dwordx4 v6, s[44:47], s62 offen lds
ds_read_b128 v[116:119], v15 offset:5120
s_waitcnt lgkmcnt(6)
v_mfma_f32_32x32x16_bf16 v[32:47], a[20:23], v[100:103], v[32:47]
ds_read_b128 v[120:123], v15 offset:6144
s_waitcnt lgkmcnt(4)
v_mfma_f32_32x32x16_bf16 v[32:47], a[24:27], v[104:107], v[32:47]
ds_read_b128 v[124:127], v15 offset:7168
s_waitcnt lgkmcnt(4)
v_mfma_f32_32x32x16_bf16 v[32:47], a[28:31], v[108:111], v[32:47]
s_waitcnt vmcnt(10)
s_barrier
ds_read_b128 v[96:99], v15 offset:8192
s_waitcnt lgkmcnt(4)
v_mfma_f32_32x32x16_bf16 v[48:63], a[16:19], v[112:115], v[48:63]
s_add_u32 m0, s16, 69632
s_add_u32 s62, s14, 5160960
buffer_load_dwordx4 v6, s[44:47], s62 offen lds
ds_read_b128 v[100:103], v15 offset:9216
s_waitcnt lgkmcnt(4)
v_mfma_f32_32x32x16_bf16 v[48:63], a[20:23], v[116:119], v[48:63]
s_add_u32 m0, s18, 126976
s_add_u32 s62, s4, 20480
buffer_load_dwordx4 v2, s[52:55], s62 offen sc1 lds
ds_read_b128 v[104:107], v15 offset:10240
s_waitcnt lgkmcnt(4)
v_mfma_f32_32x32x16_bf16 v[48:63], a[24:27], v[120:123], v[48:63]
s_add_u32 m0, s18, 131072
s_add_u32 s62, s4, 24576
buffer_load_dwordx4 v2, s[52:55], s62 offen sc1 lds
ds_read_b128 v[108:111], v15 offset:11264
s_waitcnt lgkmcnt(4)
v_mfma_f32_32x32x16_bf16 v[48:63], a[28:31], v[124:127], v[48:63]
s_add_u32 m0, s18, 0
s_add_u32 s62, s4, 28672
buffer_load_dwordx4 v2, s[52:55], s62 offen sc1 lds
ds_read_b128 v[112:115], v15 offset:12288
s_waitcnt lgkmcnt(4)
v_mfma_f32_32x32x16_bf16 v[16:31], a[32:35], v[96:99], v[16:31]
s_add_u32 m0, s16, 73728
s_add_u32 s62, s14, 5275648
buffer_load_dwordx4 v6, s[44:47], s62 offen lds
ds_read_b128 v[116:119], v15 offset:13312
s_waitcnt lgkmcnt(4)
v_mfma_f32_32x32x16_bf16 v[16:31], a[36:39], v[100:103], v[16:31]
s_add_u32 m0, s18, 4096
s_add_u32 s62, s4, 32768
buffer_load_dwordx4 v2, s[52:55], s62 offen sc1 lds
ds_read_b128 v[120:123], v15 offset:14336
s_waitcnt lgkmcnt(4)
v_mfma_f32_32x32x16_bf16 v[16:31], a[40:43], v[104:107], v[16:31]
ds_read_b128 v[124:127], v15 offset:15360
s_waitcnt lgkmcnt(4)
v_mfma_f32_32x32x16_bf16 v[16:31], a[44:47], v[108:111], v[16:31]
s_waitcnt vmcnt(14)
s_barrier
ds_read_b128 v[96:99], v15 offset:16384
s_waitcnt lgkmcnt(4)
v_mfma_f32_32x32x16_bf16 v[32:47], a[32:35], v[112:115], v[32:47]
s_add_u32 m0, s16, 77824
s_add_u32 s62, s14, 5390336
buffer_load_dwordx4 v6, s[44:47], s62 offen lds
ds_read_b128 v[100:103], v15 offset:17408
s_waitcnt lgkmcnt(4)
v_mfma_f32_32x32x16_bf16 v[32:47], a[36:39], v[116:119], v[32:47]
s_add_u32 m0, s18, 8192
s_add_u32 s62, s4, 36864
buffer_load_dwordx4 v2, s[52:55], s62 offen sc1 lds
ds_read_b128 v[104:107], v15 offset:18432
s_waitcnt lgkmcnt(4)
v_mfma_f32_32x32x16_bf16 v[32:47], a[40:43], v[120:123], v[32:47]
s_add_u32 m0, s18, 12288
s_add_u32 s62, s4, 40960
buffer_load_dwordx4 v2, s[52:55], s62 offen sc1 lds
ds_read_b128 v[108:111], v15 offset:19456
s_waitcnt lgkmcnt(4)
v_mfma_f32_32x32x16_bf16 v[32:47], a[44:47], v[124:127], v[32:47]
ds_read_b128 v[112:115], v15 offset:20480
s_waitcnt lgkmcnt(4)
v_mfma_f32_32x32x16_bf16 v[48:63], a[32:35], v[96:99], v[48:63]
s_add_u32 m0, s16, 81920
s_add_u32 s62, s14, 5505024
buffer_load_dwordx4 v6, s[44:47], s62 offen lds
ds_read_b128 v[116:119], v15 offset:21504
s_waitcnt lgkmcnt(4)
v_mfma_f32_32x32x16_bf16 v[48:63], a[36:39], v[100:103], v[48:63]
ds_read_b128 v[120:123], v15 offset:22528
s_waitcnt lgkmcnt(4)
v_mfma_f32_32x32x16_bf16 v[48:63], a[40:43], v[104:107], v[48:63]
ds_read_b128 v[124:127], v15 offset:23552
s_waitcnt lgkmcnt(4)
v_mfma_f32_32x32x16_bf16 v[48:63], a[44:47], v[108:111], v[48:63]
s_waitcnt vmcnt(16)
s_barrier
ds_read_b128 v[96:99], v15 offset:24576
s_waitcnt lgkmcnt(4)
v_mfma_f32_32x32x16_bf16 v[16:31], a[48:51], v[112:115], v[16:31]
s_add_u32 m0, s17, 86016
s_add_u32 s62, s15, 5619712
buffer_load_dwordx4 v6, s[44:47], s62 offen lds
ds_read_b128 v[100:103], v15 offset:25600
s_waitcnt lgkmcnt(4)
v_mfma_f32_32x32x16_bf16 v[16:31], a[52:55], v[116:119], v[16:31]
s_add_u32 m0, s18, 16384
s_add_u32 s62, s4, 45056
buffer_load_dwordx4 v2, s[52:55], s62 offen sc1 lds
ds_read_b128 v[104:107], v15 offset:26624
s_waitcnt lgkmcnt(4)
v_mfma_f32_32x32x16_bf16 v[16:31], a[56:59], v[120:123], v[16:31]
s_add_u32 m0, s18, 20480
s_add_u32 s62, s4, 49152
buffer_load_dwordx4 v2, s[52:55], s62 offen sc1 lds
ds_read_b128 v[108:111], v15 offset:27648
s_waitcnt lgkmcnt(4)
v_mfma_f32_32x32x16_bf16 v[16:31], a[60:63], v[124:127], v[16:31]
ds_read_b128 v[112:115], v15 offset:28672
s_waitcnt lgkmcnt(4)
v_mfma_f32_32x32x16_bf16 v[32:47], a[48:51], v[96:99], v[32:47]
s_add_u32 m0, s17, 90112
s_add_u32 s62, s15, 5734400
buffer_load_dwordx4 v6, s[44:47], s62 offen lds
ds_read_b128 v[116:119], v15 offset:29696
s_waitcnt lgkmcnt(4)
v_mfma_f32_32x32x16_bf16 v[32:47], a[52:55], v[100:103], v[32:47]
ds_read_b128 v[120:123], v15 offset:30720
s_waitcnt lgkmcnt(4)
v_mfma_f32_32x32x16_bf16 v[32:47], a[56:59], v[104:107], v[32:47]
ds_read_b128 v[124:127], v15 offset:31744
s_waitcnt lgkmcnt(4)
v_mfma_f32_32x32x16_bf16 v[32:47], a[60:63], v[108:111], v[32:47]
s_waitcnt vmcnt(16)
s_barrier
ds_read_b128 v[96:99], v13 offset:49152
s_waitcnt lgkmcnt(4)
v_mfma_f32_32x32x16_bf16 v[48:63], a[48:51], v[112:115], v[48:63]
s_add_u32 m0, s17, 94208
s_add_u32 s62, s15, 5849088
buffer_load_dwordx4 v6, s[44:47], s62 offen lds
ds_read_b128 v[100:103], v13 offset:50176
s_waitcnt lgkmcnt(4)
v_mfma_f32_32x32x16_bf16 v[48:63], a[52:55], v[116:119], v[48:63]
s_add_u32 m0, s18, 24576
s_add_u32 s62, s4, 53248
buffer_load_dwordx4 v2, s[52:55], s62 offen sc1 lds
ds_read_b128 v[104:107], v13 offset:51200
s_waitcnt lgkmcnt(4)
v_mfma_f32_32x32x16_bf16 v[48:63], a[56:59], v[120:123], v[48:63]
s_add_u32 m0, s18, 28672
s_add_u32 s62, s5, 20480
buffer_load_dwordx4 v2, s[52:55], s62 offen sc1 lds
ds_read_b128 v[108:111], v13 offset:52224
s_waitcnt lgkmcnt(4)
v_mfma_f32_32x32x16_bf16 v[48:63], a[60:63], v[124:127], v[48:63]
ds_read_b128 v[112:115], v13 offset:53248
s_waitcnt lgkmcnt(4)
v_mfma_f32_32x32x16_bf16 v[16:31], a[64:67], v[96:99], v[16:31]
s_add_u32 m0, s17, 98304
s_add_u32 s62, s15, 5963776
buffer_load_dwordx4 v6, s[44:47], s62 offen lds
ds_read_b128 v[116:119], v13 offset:54272
s_waitcnt lgkmcnt(4)
v_mfma_f32_32x32x16_bf16 v[16:31], a[68:71], v[100:103], v[16:31]
ds_read_b128 v[120:123], v13 offset:55296
s_waitcnt lgkmcnt(4)
v_mfma_f32_32x32x16_bf16 v[16:31], a[72:75], v[104:107], v[16:31]
ds_read_b128 v[124:127], v13 offset:56320
s_waitcnt lgkmcnt(4)
v_mfma_f32_32x32x16_bf16 v[16:31], a[76:79], v[108:111], v[16:31]
s_waitcnt vmcnt(16)
s_barrier
ds_read_b128 v[96:99], v13 offset:57344
s_waitcnt lgkmcnt(4)
v_mfma_f32_32x32x16_bf16 v[32:47], a[64:67], v[112:115], v[32:47]
s_add_u32 m0, s17, 102400
s_add_u32 s62, s15, 6078464
buffer_load_dwordx4 v6, s[44:47], s62 offen lds
ds_read_b128 v[100:103], v13 offset:58368
s_waitcnt lgkmcnt(4)
v_mfma_f32_32x32x16_bf16 v[32:47], a[68:71], v[116:119], v[32:47]
s_add_u32 m0, s18, 32768
s_add_u32 s62, s5, 24576
buffer_load_dwordx4 v2, s[52:55], s62 offen sc1 lds
ds_read_b128 v[104:107], v13 offset:59392
s_waitcnt lgkmcnt(4)
v_mfma_f32_32x32x16_bf16 v[32:47], a[72:75], v[120:123], v[32:47]
s_add_u32 m0, s18, 36864
s_add_u32 s62, s5, 28672
buffer_load_dwordx4 v2, s[52:55], s62 offen sc1 lds
ds_read_b128 v[108:111], v13 offset:60416
s_waitcnt lgkmcnt(4)
v_mfma_f32_32x32x16_bf16 v[32:47], a[76:79], v[124:127], v[32:47]
ds_read_b128 v[112:115], v13 offset:61440
s_waitcnt lgkmcnt(4)
v_mfma_f32_32x32x16_bf16 v[48:63], a[64:67], v[96:99], v[48:63]
s_add_u32 m0, s17, 106496
s_add_u32 s62, s15, 6193152
buffer_load_dwordx4 v6, s[44:47], s62 offen lds
ds_read_b128 v[116:119], v13 offset:62464
s_waitcnt lgkmcnt(4)
v_mfma_f32_32x32x16_bf16 v[48:63], a[68:71], v[100:103], v[48:63]
ds_read_b128 v[120:123], v13 offset:63488
s_waitcnt lgkmcnt(4)
v_mfma_f32_32x32x16_bf16 v[48:63], a[72:75], v[104:107], v[48:63]
ds_read_b128 v[124:127], v13 offset:64512
s_waitcnt lgkmcnt(4)
v_mfma_f32_32x32x16_bf16 v[48:63], a[76:79], v[108:111], v[48:63]
s_waitcnt vmcnt(18)
s_barrier
ds_read_b128 v[96:99], v15 offset:0
s_waitcnt lgkmcnt(4)
v_mfma_f32_32x32x16_bf16 v[16:31], a[80:83], v[112:115], v[16:31]
s_add_u32 m0, s17, 110592
s_add_u32 s62, s15, 6307840
buffer_load_dwordx4 v6, s[44:47], s62 offen lds
ds_read_b128 v[100:103], v15 offset:1024
s_waitcnt lgkmcnt(4)
v_mfma_f32_32x32x16_bf16 v[16:31], a[84:87], v[116:119], v[16:31]
s_add_u32 m0, s18, 40960
s_add_u32 s62, s5, 32768
buffer_load_dwordx4 v2, s[52:55], s62 offen sc1 lds
ds_read_b128 v[104:107], v15 offset:2048
s_waitcnt lgkmcnt(4)
v_mfma_f32_32x32x16_bf16 v[16:31], a[88:91], v[120:123], v[16:31]
s_add_u32 m0, s18, 45056
s_add_u32 s62, s5, 36864
buffer_load_dwordx4 v2, s[52:55], s62 offen sc1 lds
ds_read_b128 v[108:111], v15 offset:3072
s_waitcnt lgkmcnt(4)
v_mfma_f32_32x32x16_bf16 v[16:31], a[92:95], v[124:127], v[16:31]
s_add_u32 m0, s18, 49152
s_add_u32 s62, s5, 40960
buffer_load_dwordx4 v2, s[52:55], s62 offen sc1 lds
ds_read_b128 v[112:115], v2 offset:0
s_waitcnt lgkmcnt(4)
v_mfma_f32_32x32x16_bf16 v[16:31], a[96:99], v[96:99], v[16:31]
ds_read_b128 v[116:119], v2 offset:1024
s_waitcnt lgkmcnt(4)
v_mfma_f32_32x32x16_bf16 v[16:31], a[100:103], v[100:103], v[16:31]
s_add_u32 m0, s18, 53248
s_add_u32 s62, s5, 45056
buffer_load_dwordx4 v2, s[52:55], s62 offen sc1 lds
ds_read_b128 v[120:123], v2 offset:2048
s_waitcnt lgkmcnt(4)
v_mfma_f32_32x32x16_bf16 v[16:31], a[104:107], v[104:107], v[16:31]
ds_read_b128 v[124:127], v2 offset:3072
s_waitcnt lgkmcnt(4)
v_mfma_f32_32x32x16_bf16 v[16:31], a[108:111], v[108:111], v[16:31]
s_add_u32 m0, s18, 135168
s_add_u32 s62, s5, 49152
buffer_load_dwordx4 v2, s[52:55], s62 offen sc1 lds
s_waitcnt vmcnt(20)
s_barrier
ds_read_b128 v[96:99], v2 offset:4096
s_waitcnt lgkmcnt(4)
v_mfma_f32_32x32x16_bf16 v[16:31], a[112:115], v[112:115], v[16:31]
ds_read_b128 v[100:103], v2 offset:5120
s_waitcnt lgkmcnt(4)
v_mfma_f32_32x32x16_bf16 v[16:31], a[116:119], v[116:119], v[16:31]
s_add_u32 m0, s18, 139264
s_add_u32 s62, s5, 53248
buffer_load_dwordx4 v2, s[52:55], s62 offen sc1 lds
ds_read_b128 v[104:107], v2 offset:6144
s_waitcnt lgkmcnt(4)
v_mfma_f32_32x32x16_bf16 v[16:31], a[120:123], v[120:123], v[16:31]
ds_read_b128 v[108:111], v2 offset:7168
s_waitcnt lgkmcnt(4)
v_mfma_f32_32x32x16_bf16 v[16:31], a[124:127], v[124:127], v[16:31]
s_add_u32 m0, s18, 143360
s_add_u32 s62, s7, 20480
buffer_load_dwordx4 v2, s[52:55], s62 offen sc1 lds
ds_read_b128 v[112:115], v2 offset:8192
s_waitcnt lgkmcnt(4)
v_mfma_f32_32x32x16_bf16 v[16:31], a[128:131], v[96:99], v[16:31]
ds_read_b128 v[116:119], v2 offset:9216
s_waitcnt lgkmcnt(4)
v_mfma_f32_32x32x16_bf16 v[16:31], a[132:135], v[100:103], v[16:31]
s_add_u32 m0, s18, 147456
s_add_u32 s62, s7, 24576
buffer_load_dwordx4 v2, s[52:55], s62 offen sc1 lds
ds_read_b128 v[120:123], v2 offset:10240
s_waitcnt lgkmcnt(4)
v_mfma_f32_32x32x16_bf16 v[16:31], a[136:139], v[104:107], v[16:31]
ds_read_b128 v[124:127], v2 offset:11264
s_waitcnt lgkmcnt(4)
v_mfma_f32_32x32x16_bf16 v[16:31], a[140:143], v[108:111], v[16:31]
s_add_u32 m0, s18, 151552
s_add_u32 s62, s7, 28672
buffer_load_dwordx4 v2, s[52:55], s62 offen sc1 lds
s_waitcnt vmcnt(20)
s_waitcnt vmcnt(9)
s_barrier
ds_read_b128 v[96:99], v2 offset:12288
s_waitcnt lgkmcnt(4)
v_mfma_f32_32x32x16_bf16 v[16:31], a[144:147], v[112:115], v[16:31]
ds_read_b64_tr_b16 a[168:169], v146 offset:57344
ds_read_b64_tr_b16 a[170:171], v146 offset:58368
ds_read_b128 v[100:103], v2 offset:13312
s_waitcnt lgkmcnt(6)
v_mfma_f32_32x32x16_bf16 v[16:31], a[148:151], v[116:119], v[16:31]
s_add_u32 m0, s18, 155648
s_add_u32 s62, s7, 32768
buffer_load_dwordx4 v2, s[52:55], s62 offen sc1 lds
ds_read_b64_tr_b16 a[172:173], v146 offset:61440
ds_read_b64_tr_b16 a[174:175], v146 offset:62464
ds_read_b128 v[104:107], v2 offset:14336
s_waitcnt lgkmcnt(8)
v_mfma_f32_32x32x16_bf16 v[16:31], a[152:155], v[120:123], v[16:31]
ds_read_b64_tr_b16 a[176:177], v147 offset:0
ds_read_b64_tr_b16 a[178:179], v147 offset:1024
ds_read_b128 v[108:111], v2 offset:15360
s_waitcnt lgkmcnt(10)
v_mfma_f32_32x32x16_bf16 v[16:31], a[156:159], v[124:127], v[16:31]
s_add_u32 m0, s18, 159744
s_add_u32 s62, s7, 36864
buffer_load_dwordx4 v2, s[52:55], s62 offen sc1 lds
ds_read_b64_tr_b16 a[180:181], v147 offset:4096
ds_read_b64_tr_b16 a[182:183], v147 offset:5120
ds_read_b128 v[112:115], v2 offset:16384
s_waitcnt lgkmcnt(12)
v_mfma_f32_32x32x16_bf16 v[16:31], a[160:163], v[96:99], v[16:31]
ds_read_b64_tr_b16 a[184:185], v147 offset:8192
ds_read_b64_tr_b16 a[186:187], v147 offset:9216
ds_read_b128 v[116:119], v2 offset:17408
s_waitcnt lgkmcnt(12)
v_mfma_f32_32x32x16_bf16 v[16:31], a[164:167], v[100:103], v[16:31]
s_add_u32 m0, s18, 114688
s_add_u32 s62, s7, 40960
buffer_load_dwordx4 v2, s[52:55], s62 offen sc1 lds
ds_read_b64_tr_b16 a[188:189], v147 offset:12288
ds_read_b64_tr_b16 a[190:191], v147 offset:13312
ds_read_b128 v[120:123], v2 offset:18432
s_waitcnt lgkmcnt(12)
v_mfma_f32_32x32x16_bf16 v[16:31], a[168:171], v[104:107], v[16:31]
ds_read_b64_tr_b16 a[192:193], v147 offset:16384
ds_read_b64_tr_b16 a[194:195], v147 offset:17408
ds_read_b128 v[124:127], v2 offset:19456
s_waitcnt lgkmcnt(12)
v_mfma_f32_32x32x16_bf16 v[16:31], a[172:175], v[108:111], v[16:31]
s_add_u32 m0, s18, 118784
s_add_u32 s62, s7, 45056
buffer_load_dwordx4 v2, s[52:55], s62 offen sc1 lds
ds_read_b64_tr_b16 a[196:197], v147 offset:20480
ds_read_b64_tr_b16 a[198:199], v147 offset:21504
s_barrier
ds_read_b128 v[96:99], v2 offset:20480
s_waitcnt lgkmcnt(12)
v_mfma_f32_32x32x16_bf16 v[16:31], a[176:179], v[112:115], v[16:31]
ds_read_b64_tr_b16 a[200:201], v147 offset:24576
ds_read_b64_tr_b16 a[202:203], v147 offset:25600
ds_read_b128 v[100:103], v2 offset:21504
s_waitcnt lgkmcnt(12)
v_mfma_f32_32x32x16_bf16 v[16:31], a[180:183], v[116:119], v[16:31]
s_add_u32 m0, s18, 122880
s_add_u32 s62, s7, 49152
buffer_load_dwordx4 v2, s[52:55], s62 offen sc1 lds
ds_read_b64_tr_b16 a[204:205], v147 offset:28672
ds_read_b64_tr_b16 a[206:207], v147 offset:29696
ds_read_b128 v[104:107], v2 offset:22528
s_waitcnt lgkmcnt(12)
v_mfma_f32_32x32x16_bf16 v[16:31], a[184:187], v[120:123], v[16:31]
ds_read_b64_tr_b16 a[208:209], v147 offset:32768
ds_read_b64_tr_b16 a[210:211], v147 offset:33792
ds_read_b128 v[108:111], v2 offset:23552
s_waitcnt lgkmcnt(12)
v_mfma_f32_32x32x16_bf16 v[16:31], a[188:191], v[124:127], v[16:31]
s_add_u32 m0, s18, 126976
s_add_u32 s62, s7, 53248
buffer_load_dwordx4 v2, s[52:55], s62 offen sc1 lds
ds_read_b64_tr_b16 a[212:213], v147 offset:36864
ds_read_b64_tr_b16 a[214:215], v147 offset:37888
ds_read_b128 v[112:115], v2 offset:24576
s_waitcnt lgkmcnt(12)
v_mfma_f32_32x32x16_bf16 v[16:31], a[192:195], v[96:99], v[16:31]
ds_read_b64_tr_b16 a[216:217], v147 offset:40960
ds_read_b64_tr_b16 a[218:219], v147 offset:41984
ds_read_b128 v[116:119], v2 offset:25600
s_waitcnt lgkmcnt(12)
v_mfma_f32_32x32x16_bf16 v[16:31], a[196:199], v[100:103], v[16:31]
s_add_u32 m0, s18, 131072
s_add_u32 s62, s8, 0
buffer_load_dwordx4 v2, s[52:55], s62 offen sc1 lds
ds_read_b64_tr_b16 a[220:221], v147 offset:45056
ds_read_b64_tr_b16 a[222:223], v147 offset:46080
ds_read_b128 v[120:123], v2 offset:26624
s_waitcnt lgkmcnt(12)
v_mfma_f32_32x32x16_bf16 v[16:31], a[200:203], v[104:107], v[16:31]
ds_read_b128 v[124:127], v2 offset:27648
s_waitcnt lgkmcnt(10)
v_mfma_f32_32x32x16_bf16 v[16:31], a[204:207], v[108:111], v[16:31]
s_add_u32 m0, s18, 0
s_add_u32 s62, s8, 4096
buffer_load_dwordx4 v2, s[52:55], s62 offen sc1 lds
s_barrier
ds_read_b128 v[96:99], v2 offset:28672
s_waitcnt lgkmcnt(8)
v_mfma_f32_32x32x16_bf16 v[16:31], a[208:211], v[112:115], v[16:31]
ds_read_b128 v[100:103], v2 offset:29696
s_waitcnt lgkmcnt(6)
v_mfma_f32_32x32x16_bf16 v[16:31], a[212:215], v[116:119], v[16:31]
s_add_u32 m0, s18, 4096
s_add_u32 s62, s8, 8192
buffer_load_dwordx4 v2, s[52:55], s62 offen sc1 lds
ds_read_b128 v[104:107], v2 offset:30720
s_waitcnt lgkmcnt(4)
v_mfma_f32_32x32x16_bf16 v[16:31], a[216:219], v[120:123], v[16:31]
ds_read_b128 v[108:111], v2 offset:31744
s_waitcnt lgkmcnt(4)
v_mfma_f32_32x32x16_bf16 v[16:31], a[220:223], v[124:127], v[16:31]
s_add_u32 m0, s18, 8192
s_add_u32 s62, s8, 12288
buffer_load_dwordx4 v2, s[52:55], s62 offen sc1 lds
ds_read_b128 v[112:115], v2 offset:32768
s_waitcnt lgkmcnt(4)
v_mfma_f32_32x32x16_bf16 v[32:47], a[80:83], v[96:99], v[32:47]
ds_read_b128 v[116:119], v2 offset:33792
s_waitcnt lgkmcnt(4)
v_mfma_f32_32x32x16_bf16 v[32:47], a[84:87], v[100:103], v[32:47]
ds_read_b128 v[120:123], v2 offset:34816
s_waitcnt lgkmcnt(4)
v_mfma_f32_32x32x16_bf16 v[32:47], a[88:91], v[104:107], v[32:47]
v_and_or_b32 v16, v16, s27, v12
v_and_or_b32 v17, v17, s27, v12
v_and_or_b32 v18, v18, s27, v12
v_and_or_b32 v19, v19, s27, v12
ds_read_b128 v[124:127], v2 offset:35840
s_waitcnt lgkmcnt(4)
v_mfma_f32_32x32x16_bf16 v[32:47], a[92:95], v[108:111], v[32:47]
s_add_u32 s61, s9, 1
s_and_b32 s61, s61, 3
s_lshl_b32 s61, s61, 16
s_add_u32 s22, s61, s12
buffer_store_dwordx4 v[16:19], v2, s[52:55], s22 offen sc1
v_and_or_b32 v20, v20, s27, v12
v_and_or_b32 v21, v21, s27, v12
v_and_or_b32 v22, v22, s27, v12
v_and_or_b32 v23, v23, s27, v12
s_waitcnt vmcnt(19)
s_barrier
ds_read_b128 v[96:99], v2 offset:36864
s_waitcnt lgkmcnt(4)
v_mfma_f32_32x32x16_bf16 v[32:47], a[96:99], v[112:115], v[32:47]
buffer_store_dwordx4 v[20:23], v2, s[52:55], s22 offen offset:1024 sc1
v_and_or_b32 v24, v24, s27, v12
v_and_or_b32 v25, v25, s27, v12
v_and_or_b32 v26, v26, s27, v12
v_and_or_b32 v27, v27, s27, v12
ds_read_b128 v[100:103], v2 offset:37888
s_waitcnt lgkmcnt(4)
v_mfma_f32_32x32x16_bf16 v[32:47], a[100:103], v[116:119], v[32:47]
buffer_store_dwordx4 v[24:27], v2, s[52:55], s22 offen offset:2048 sc1
v_and_or_b32 v28, v28, s27, v12
v_and_or_b32 v29, v29, s27, v12
v_and_or_b32 v30, v30, s27, v12
v_and_or_b32 v31, v31, s27, v12
ds_read_b128 v[104:107], v2 offset:38912
s_waitcnt lgkmcnt(4)
v_mfma_f32_32x32x16_bf16 v[32:47], a[104:107], v[120:123], v[32:47]
buffer_store_dwordx4 v[28:31], v2, s[52:55], s22 offen offset:3072 sc1
ds_read_b128 v[108:111], v2 offset:39936
s_waitcnt lgkmcnt(4)
v_mfma_f32_32x32x16_bf16 v[32:47], a[108:111], v[124:127], v[32:47]
s_add_u32 m0, s18, 12288
s_add_u32 s62, s8, 16384
buffer_load_dwordx4 v2, s[52:55], s62 offen sc1 lds
ds_read_b128 v[112:115], v2 offset:40960
s_waitcnt lgkmcnt(4)
v_mfma_f32_32x32x16_bf16 v[32:47], a[112:115], v[96:99], v[32:47]
ds_read_b128 v[116:119], v2 offset:41984
s_waitcnt lgkmcnt(4)
v_mfma_f32_32x32x16_bf16 v[32:47], a[116:119], v[100:103], v[32:47]
s_add_u32 m0, s18, 16384
s_add_u32 s62, s8, 20480
buffer_load_dwordx4 v2, s[52:55], s62 offen sc1 lds
ds_read_b128 v[120:123], v2 offset:43008
s_waitcnt lgkmcnt(4)
v_mfma_f32_32x32x16_bf16 v[32:47], a[120:123], v[104:107], v[32:47]
ds_read_b128 v[124:127], v2 offset:44032
s_waitcnt lgkmcnt(4)
v_mfma_f32_32x32x16_bf16 v[32:47], a[124:127], v[108:111], v[32:47]
s_waitcnt vmcnt(22)
s_barrier
ds_read_b128 v[96:99], v2 offset:45056
s_waitcnt lgkmcnt(4)
v_mfma_f32_32x32x16_bf16 v[32:47], a[128:131], v[112:115], v[32:47]
ds_read_b128 v[100:103], v2 offset:46080
s_waitcnt lgkmcnt(4)
v_mfma_f32_32x32x16_bf16 v[32:47], a[132:135], v[116:119], v[32:47]
s_add_u32 m0, s18, 20480
s_add_u32 s62, s8, 24576
buffer_load_dwordx4 v2, s[52:55], s62 offen sc1 lds
ds_read_b128 v[104:107], v2 offset:47104
s_waitcnt lgkmcnt(4)
v_mfma_f32_32x32x16_bf16 v[32:47], a[136:139], v[120:123], v[32:47]
ds_read_b128 v[108:111], v2 offset:48128
s_waitcnt lgkmcnt(4)
v_mfma_f32_32x32x16_bf16 v[32:47], a[140:143], v[124:127], v[32:47]
s_add_u32 m0, s18, 24576
s_add_u32 s62, s8, 28672
buffer_load_dwordx4 v2, s[52:55], s62 offen sc1 lds
ds_read_b128 v[112:115], v2 offset:49152
s_waitcnt lgkmcnt(4)
v_mfma_f32_32x32x16_bf16 v[32:47], a[144:147], v[96:99], v[32:47]
ds_read_b128 v[116:119], v2 offset:50176
s_waitcnt lgkmcnt(4)
v_mfma_f32_32x32x16_bf16 v[32:47], a[148:151], v[100:103], v[32:47]
ds_read_b128 v[120:123], v2 offset:51200
s_waitcnt lgkmcnt(4)
v_mfma_f32_32x32x16_bf16 v[32:47], a[152:155], v[104:107], v[32:47]
ds_read_b128 v[124:127], v2 offset:52224
s_waitcnt lgkmcnt(4)
v_mfma_f32_32x32x16_bf16 v[32:47], a[156:159], v[108:111], v[32:47]
s_waitcnt vmcnt(22)
s_barrier
ds_read_b128 v[96:99], v2 offset:53248
s_waitcnt lgkmcnt(4)
v_mfma_f32_32x32x16_bf16 v[32:47], a[160:163], v[112:115], v[32:47]
ds_read_b128 v[100:103], v2 offset:54272
s_waitcnt lgkmcnt(4)
v_mfma_f32_32x32x16_bf16 v[32:47], a[164:167], v[116:119], v[32:47]
s_add_u32 m0, s18, 28672
s_add_u32 s62, s8, 32768
buffer_load_dwordx4 v2, s[52:55], s62 offen sc1 lds
ds_read_b128 v[104:107], v2 offset:55296
s_waitcnt lgkmcnt(4)
v_mfma_f32_32x32x16_bf16 v[32:47], a[168:171], v[120:123], v[32:47]
ds_read_b128 v[108:111], v2 offset:56320
s_waitcnt lgkmcnt(4)
v_mfma_f32_32x32x16_bf16 v[32:47], a[172:175], v[124:127], v[32:47]
s_add_u32 m0, s18, 57344
s_add_u32 s62, s8, 36864
buffer_load_dwordx4 v2, s[52:55], s62 offen sc1 lds
ds_read_b128 v[112:115], v15 offset:4096
s_waitcnt lgkmcnt(4)
v_mfma_f32_32x32x16_bf16 v[32:47], a[176:179], v[96:99], v[32:47]
ds_read_b128 v[116:119], v15 offset:5120
s_waitcnt lgkmcnt(4)
v_mfma_f32_32x32x16_bf16 v[32:47], a[180:183], v[100:103], v[32:47]
ds_read_b128 v[120:123], v15 offset:6144
s_waitcnt lgkmcnt(4)
v_mfma_f32_32x32x16_bf16 v[32:47], a[184:187], v[104:107], v[32:47]
ds_read_b128 v[124:127], v15 offset:7168
s_waitcnt lgkmcnt(4)
v_mfma_f32_32x32x16_bf16 v[32:47], a[188:191], v[108:111], v[32:47]
s_waitcnt vmcnt(22)
s_barrier
ds_read_b128 v[96:99], v15 offset:8192
s_waitcnt lgkmcnt(4)
v_mfma_f32_32x32x16_bf16 v[32:47], a[192:195], v[112:115], v[32:47]
ds_read_b128 v[100:103], v15 offset:9216
s_waitcnt lgkmcnt(4)
v_mfma_f32_32x32x16_bf16 v[32:47], a[196:199], v[116:119], v[32:47]
s_add_u32 m0, s18, 61440
s_add_u32 s62, s8, 40960
buffer_load_dwordx4 v2, s[52:55], s62 offen sc1 lds
ds_read_b128 v[104:107], v15 offset:10240
s_waitcnt lgkmcnt(4)
v_mfma_f32_32x32x16_bf16 v[32:47], a[200:203], v[120:123], v[32:47]
ds_read_b128 v[108:111], v15 offset:11264
s_waitcnt lgkmcnt(4)
v_mfma_f32_32x32x16_bf16 v[32:47], a[204:207], v[124:127], v[32:47]
s_add_u32 m0, s18, 65536
s_add_u32 s62, s8, 45056
buffer_load_dwordx4 v2, s[52:55], s62 offen sc1 lds
ds_read_b128 v[112:115], v15 offset:12288
s_waitcnt lgkmcnt(4)
v_mfma_f32_32x32x16_bf16 v[32:47], a[208:211], v[96:99], v[32:47]
ds_read_b128 v[116:119], v15 offset:13312
s_waitcnt lgkmcnt(4)
v_mfma_f32_32x32x16_bf16 v[32:47], a[212:215], v[100:103], v[32:47]
ds_read_b128 v[120:123], v15 offset:14336
s_waitcnt lgkmcnt(4)
v_mfma_f32_32x32x16_bf16 v[32:47], a[216:219], v[104:107], v[32:47]
ds_read_b128 v[124:127], v15 offset:15360
s_waitcnt lgkmcnt(4)
v_mfma_f32_32x32x16_bf16 v[32:47], a[220:223], v[108:111], v[32:47]
s_waitcnt vmcnt(22)
s_barrier
ds_read_b128 v[96:99], v15 offset:16384
s_waitcnt lgkmcnt(4)
v_mfma_f32_32x32x16_bf16 v[48:63], a[80:83], v[112:115], v[48:63]
ds_read_b128 v[100:103], v15 offset:17408
s_waitcnt lgkmcnt(4)
v_mfma_f32_32x32x16_bf16 v[48:63], a[84:87], v[116:119], v[48:63]
s_add_u32 m0, s18, 69632
s_add_u32 s62, s8, 49152
buffer_load_dwordx4 v2, s[52:55], s62 offen sc1 lds
ds_read_b128 v[104:107], v15 offset:18432
s_waitcnt lgkmcnt(4)
v_mfma_f32_32x32x16_bf16 v[48:63], a[88:91], v[120:123], v[48:63]
v_and_or_b32 v32, v32, s27, v12
v_and_or_b32 v33, v33, s27, v12
v_and_or_b32 v34, v34, s27, v12
v_and_or_b32 v35, v35, s27, v12
ds_read_b128 v[108:111], v15 offset:19456
s_waitcnt lgkmcnt(4)
v_mfma_f32_32x32x16_bf16 v[48:63], a[92:95], v[124:127], v[48:63]
s_add_u32 s61, s9, 2
s_and_b32 s61, s61, 3
s_lshl_b32 s61, s61, 16
s_add_u32 s22, s61, s12
buffer_store_dwordx4 v[32:35], v2, s[52:55], s22 offen sc1
v_and_or_b32 v36, v36, s27, v12
v_and_or_b32 v37, v37, s27, v12
v_and_or_b32 v38, v38, s27, v12
v_and_or_b32 v39, v39, s27, v12
ds_read_b128 v[112:115], v15 offset:20480
s_waitcnt lgkmcnt(4)
v_mfma_f32_32x32x16_bf16 v[48:63], a[96:99], v[96:99], v[48:63]
buffer_store_dwordx4 v[36:39], v2, s[52:55], s22 offen offset:1024 sc1
v_and_or_b32 v40, v40, s27, v12
v_and_or_b32 v41, v41, s27, v12
v_and_or_b32 v42, v42, s27, v12
v_and_or_b32 v43, v43, s27, v12
ds_read_b128 v[116:119], v15 offset:21504
s_waitcnt lgkmcnt(4)
v_mfma_f32_32x32x16_bf16 v[48:63], a[100:103], v[100:103], v[48:63]
buffer_store_dwordx4 v[40:43], v2, s[52:55], s22 offen offset:2048 sc1
v_and_or_b32 v44, v44, s27, v12
v_and_or_b32 v45, v45, s27, v12
v_and_or_b32 v46, v46, s27, v12
v_and_or_b32 v47, v47, s27, v12
ds_read_b128 v[120:123], v15 offset:22528
s_waitcnt lgkmcnt(4)
v_mfma_f32_32x32x16_bf16 v[48:63], a[104:107], v[104:107], v[48:63]
buffer_store_dwordx4 v[44:47], v2, s[52:55], s22 offen offset:3072 sc1
ds_read_b128 v[124:127], v15 offset:23552
s_waitcnt lgkmcnt(4)
v_mfma_f32_32x32x16_bf16 v[48:63], a[108:111], v[108:111], v[48:63]
s_add_u32 m0, s18, 73728
s_add_u32 s62, s8, 53248
buffer_load_dwordx4 v2, s[52:55], s62 offen sc1 lds
s_waitcnt vmcnt(26)
s_barrier
ds_read_b128 v[96:99], v15 offset:24576
s_waitcnt lgkmcnt(4)
v_mfma_f32_32x32x16_bf16 v[48:63], a[112:115], v[112:115], v[48:63]
ds_read_b128 v[100:103], v15 offset:25600
s_waitcnt lgkmcnt(4)
v_mfma_f32_32x32x16_bf16 v[48:63], a[116:119], v[116:119], v[48:63]
ds_read_b128 v[104:107], v15 offset:26624
s_waitcnt lgkmcnt(4)
v_mfma_f32_32x32x16_bf16 v[48:63], a[120:123], v[120:123], v[48:63]
ds_read_b128 v[108:111], v15 offset:27648
s_waitcnt lgkmcnt(4)
v_mfma_f32_32x32x16_bf16 v[48:63], a[124:127], v[124:127], v[48:63]
ds_read_b128 v[112:115], v15 offset:28672
s_waitcnt lgkmcnt(4)
v_mfma_f32_32x32x16_bf16 v[48:63], a[128:131], v[96:99], v[48:63]
ds_read_b128 v[116:119], v15 offset:29696
s_waitcnt lgkmcnt(4)
v_mfma_f32_32x32x16_bf16 v[48:63], a[132:135], v[100:103], v[48:63]
ds_read_b128 v[120:123], v15 offset:30720
s_waitcnt lgkmcnt(4)
v_mfma_f32_32x32x16_bf16 v[48:63], a[136:139], v[104:107], v[48:63]
ds_read_b128 v[124:127], v15 offset:31744
s_waitcnt lgkmcnt(4)
v_mfma_f32_32x32x16_bf16 v[48:63], a[140:143], v[108:111], v[48:63]
s_waitcnt vmcnt(24)
s_barrier
ds_read_b128 v[96:99], v13 offset:49152
s_waitcnt lgkmcnt(4)
v_mfma_f32_32x32x16_bf16 v[48:63], a[144:147], v[112:115], v[48:63]
ds_read_b128 v[100:103], v13 offset:50176
s_waitcnt lgkmcnt(4)
v_mfma_f32_32x32x16_bf16 v[48:63], a[148:151], v[116:119], v[48:63]
ds_read_b128 v[104:107], v13 offset:51200
s_waitcnt lgkmcnt(4)
v_mfma_f32_32x32x16_bf16 v[48:63], a[152:155], v[120:123], v[48:63]
ds_read_b128 v[108:111], v13 offset:52224
s_waitcnt lgkmcnt(4)
v_mfma_f32_32x32x16_bf16 v[48:63], a[156:159], v[124:127], v[48:63]
ds_read_b128 v[112:115], v13 offset:53248
s_waitcnt lgkmcnt(4)
v_mfma_f32_32x32x16_bf16 v[48:63], a[160:163], v[96:99], v[48:63]
ds_read_b128 v[116:119], v13 offset:54272
s_waitcnt lgkmcnt(4)
v_mfma_f32_32x32x16_bf16 v[48:63], a[164:167], v[100:103], v[48:63]
ds_read_b128 v[120:123], v13 offset:55296
s_waitcnt lgkmcnt(4)
v_mfma_f32_32x32x16_bf16 v[48:63], a[168:171], v[104:107], v[48:63]
ds_read_b128 v[124:127], v13 offset:56320
s_waitcnt lgkmcnt(4)
v_mfma_f32_32x32x16_bf16 v[48:63], a[172:175], v[108:111], v[48:63]
s_waitcnt vmcnt(22)
s_barrier
ds_read_b128 v[96:99], v13 offset:57344
s_waitcnt lgkmcnt(4)
v_mfma_f32_32x32x16_bf16 v[48:63], a[176:179], v[112:115], v[48:63]
ds_read_b128 v[100:103], v13 offset:58368
s_waitcnt lgkmcnt(4)
v_mfma_f32_32x32x16_bf16 v[48:63], a[180:183], v[116:119], v[48:63]
ds_read_b128 v[104:107], v13 offset:59392
s_waitcnt lgkmcnt(4)
v_mfma_f32_32x32x16_bf16 v[48:63], a[184:187], v[120:123], v[48:63]
ds_read_b128 v[108:111], v13 offset:60416
s_waitcnt lgkmcnt(4)
v_mfma_f32_32x32x16_bf16 v[48:63], a[188:191], v[124:127], v[48:63]
ds_read_b128 v[112:115], v13 offset:61440
s_waitcnt lgkmcnt(4)
v_mfma_f32_32x32x16_bf16 v[48:63], a[192:195], v[96:99], v[48:63]
ds_read_b128 v[116:119], v13 offset:62464
s_waitcnt lgkmcnt(4)
v_mfma_f32_32x32x16_bf16 v[48:63], a[196:199], v[100:103], v[48:63]
buffer_load_dwordx4 v[192:195], v2, s[52:55], s24 offen offset:0 sc1
ds_read_b128 v[120:123], v13 offset:63488
s_waitcnt lgkmcnt(4)
v_mfma_f32_32x32x16_bf16 v[48:63], a[200:203], v[104:107], v[48:63]
buffer_load_dwordx4 v[196:199], v2, s[52:55], s24 offen offset:1024 sc1
ds_read_b128 v[124:127], v13 offset:64512
s_waitcnt lgkmcnt(4)
v_mfma_f32_32x32x16_bf16 v[48:63], a[204:207], v[108:111], v[48:63]
buffer_load_dwordx4 v[200:203], v2, s[52:55], s24 offen offset:2048 sc1
s_waitcnt vmcnt(23)
s_barrier
ds_read_b128 v[96:99], v15 offset:0
s_waitcnt lgkmcnt(4)
v_mfma_f32_32x32x16_bf16 v[48:63], a[208:211], v[112:115], v[48:63]
buffer_load_dwordx4 v[204:207], v2, s[52:55], s24 offen offset:3072 sc1
ds_read_b128 v[100:103], v15 offset:1024
s_waitcnt lgkmcnt(4)
v_mfma_f32_32x32x16_bf16 v[48:63], a[212:215], v[116:119], v[48:63]
ds_read_b128 v[104:107], v15 offset:2048
s_waitcnt lgkmcnt(4)
v_mfma_f32_32x32x16_bf16 v[48:63], a[216:219], v[120:123], v[48:63]
ds_read_b128 v[108:111], v15 offset:3072
s_waitcnt lgkmcnt(4)
v_mfma_f32_32x32x16_bf16 v[48:63], a[220:223], v[124:127], v[48:63]
ds_read_b128 v[112:115], v2 offset:0
s_waitcnt lgkmcnt(4)
v_mfma_f32_32x32x16_bf16 v[64:79], a[0:3], v[96:99], 0
ds_read_b128 v[116:119], v2 offset:1024
s_waitcnt lgkmcnt(4)
v_mfma_f32_32x32x16_bf16 v[64:79], a[4:7], v[100:103], v[64:79]
ds_read_b128 v[120:123], v2 offset:2048
s_waitcnt lgkmcnt(4)
v_mfma_f32_32x32x16_bf16 v[64:79], a[8:11], v[104:107], v[64:79]
v_and_or_b32 v48, v48, s27, v12
v_and_or_b32 v49, v49, s27, v12
v_and_or_b32 v50, v50, s27, v12
v_and_or_b32 v51, v51, s27, v12
ds_read_b128 v[124:127], v2 offset:3072
s_waitcnt lgkmcnt(4)
v_mfma_f32_32x32x16_bf16 v[64:79], a[12:15], v[108:111], v[64:79]
s_add_u32 s61, s9, 3
s_and_b32 s61, s61, 3
s_lshl_b32 s61, s61, 16
s_add_u32 s22, s61, s12
buffer_store_dwordx4 v[48:51], v2, s[52:55], s22 offen sc1
v_and_or_b32 v52, v52, s27, v12
v_and_or_b32 v53, v53, s27, v12
v_and_or_b32 v54, v54, s27, v12
v_and_or_b32 v55, v55, s27, v12
s_waitcnt vmcnt(23)
s_barrier
ds_read_b128 v[96:99], v2 offset:4096
s_waitcnt lgkmcnt(4)
v_mfma_f32_32x32x16_bf16 v[64:79], a[16:19], v[112:115], v[64:79]
buffer_store_dwordx4 v[52:55], v2, s[52:55], s22 offen offset:1024 sc1
v_and_or_b32 v56, v56, s27, v12
v_and_or_b32 v57, v57, s27, v12
v_and_or_b32 v58, v58, s27, v12
v_and_or_b32 v59, v59, s27, v12
ds_read_b128 v[100:103], v2 offset:5120
s_waitcnt lgkmcnt(4)
v_mfma_f32_32x32x16_bf16 v[64:79], a[20:23], v[116:119], v[64:79]
buffer_store_dwordx4 v[56:59], v2, s[52:55], s22 offen offset:2048 sc1
v_and_or_b32 v60, v60, s27, v12
v_and_or_b32 v61, v61, s27, v12
v_and_or_b32 v62, v62, s27, v12
v_and_or_b32 v63, v63, s27, v12
ds_read_b128 v[104:107], v2 offset:6144
s_waitcnt lgkmcnt(4)
v_mfma_f32_32x32x16_bf16 v[64:79], a[24:27], v[120:123], v[64:79]
buffer_store_dwordx4 v[60:63], v2, s[52:55], s22 offen offset:3072 sc1
ds_read_b128 v[108:111], v2 offset:7168
s_waitcnt lgkmcnt(4)
v_mfma_f32_32x32x16_bf16 v[64:79], a[28:31], v[124:127], v[64:79]
ds_read_b128 v[112:115], v2 offset:8192
s_waitcnt lgkmcnt(4)
v_mfma_f32_32x32x16_bf16 v[64:79], a[32:35], v[96:99], v[64:79]
ds_read_b128 v[116:119], v2 offset:9216
s_waitcnt lgkmcnt(4)
v_mfma_f32_32x32x16_bf16 v[64:79], a[36:39], v[100:103], v[64:79]
ds_read_b128 v[120:123], v2 offset:10240
s_waitcnt lgkmcnt(4)
v_mfma_f32_32x32x16_bf16 v[64:79], a[40:43], v[104:107], v[64:79]
ds_read_b128 v[124:127], v2 offset:11264
s_waitcnt lgkmcnt(4)
v_mfma_f32_32x32x16_bf16 v[64:79], a[44:47], v[108:111], v[64:79]
s_waitcnt vmcnt(20)
s_barrier
ds_read_b128 v[96:99], v2 offset:12288
s_waitcnt lgkmcnt(4)
v_mfma_f32_32x32x16_bf16 v[64:79], a[48:51], v[112:115], v[64:79]
ds_read_b128 v[100:103], v2 offset:13312
s_waitcnt lgkmcnt(4)
v_mfma_f32_32x32x16_bf16 v[64:79], a[52:55], v[116:119], v[64:79]
ds_read_b128 v[104:107], v2 offset:14336
s_waitcnt lgkmcnt(4)
v_mfma_f32_32x32x16_bf16 v[64:79], a[56:59], v[120:123], v[64:79]
ds_read_b128 v[108:111], v2 offset:15360
s_waitcnt lgkmcnt(4)
v_mfma_f32_32x32x16_bf16 v[64:79], a[60:63], v[124:127], v[64:79]
ds_read_b128 v[112:115], v2 offset:16384
s_waitcnt lgkmcnt(4)
v_mfma_f32_32x32x16_bf16 v[64:79], a[64:67], v[96:99], v[64:79]
ds_read_b128 v[116:119], v2 offset:17408
s_waitcnt lgkmcnt(4)
v_mfma_f32_32x32x16_bf16 v[64:79], a[68:71], v[100:103], v[64:79]
ds_read_b128 v[120:123], v2 offset:18432
s_waitcnt lgkmcnt(4)
v_mfma_f32_32x32x16_bf16 v[64:79], a[72:75], v[104:107], v[64:79]
ds_read_b128 v[124:127], v2 offset:19456
s_waitcnt lgkmcnt(4)
v_mfma_f32_32x32x16_bf16 v[64:79], a[76:79], v[108:111], v[64:79]
s_waitcnt vmcnt(18)
s_barrier
ds_read_b128 v[96:99], v2 offset:20480
s_waitcnt lgkmcnt(4)
v_mfma_f32_32x32x16_bf16 v[64:79], a[80:83], v[112:115], v[64:79]
ds_read_b128 v[100:103], v2 offset:21504
s_waitcnt lgkmcnt(4)
v_mfma_f32_32x32x16_bf16 v[64:79], a[84:87], v[116:119], v[64:79]
ds_read_b128 v[104:107], v2 offset:22528
s_waitcnt lgkmcnt(4)
v_mfma_f32_32x32x16_bf16 v[64:79], a[88:91], v[120:123], v[64:79]
ds_read_b128 v[108:111], v2 offset:23552
s_waitcnt lgkmcnt(4)
v_mfma_f32_32x32x16_bf16 v[64:79], a[92:95], v[124:127], v[64:79]
ds_read_b128 v[112:115], v2 offset:24576
s_waitcnt lgkmcnt(4)
v_mfma_f32_32x32x16_bf16 v[64:79], a[96:99], v[96:99], v[64:79]
ds_read_b128 v[116:119], v2 offset:25600
s_waitcnt lgkmcnt(4)
v_mfma_f32_32x32x16_bf16 v[64:79], a[100:103], v[100:103], v[64:79]
ds_read_b128 v[120:123], v2 offset:26624
s_waitcnt lgkmcnt(4)
v_mfma_f32_32x32x16_bf16 v[64:79], a[104:107], v[104:107], v[64:79]
ds_read_b128 v[124:127], v2 offset:27648
s_waitcnt lgkmcnt(4)
v_mfma_f32_32x32x16_bf16 v[64:79], a[108:111], v[108:111], v[64:79]
s_waitcnt vmcnt(16)
s_barrier
ds_read_b128 v[96:99], v2 offset:28672
s_waitcnt lgkmcnt(4)
v_mfma_f32_32x32x16_bf16 v[64:79], a[112:115], v[112:115], v[64:79]
ds_read_b128 v[100:103], v2 offset:29696
s_waitcnt lgkmcnt(4)
v_mfma_f32_32x32x16_bf16 v[64:79], a[116:119], v[116:119], v[64:79]
ds_read_b128 v[104:107], v2 offset:30720
s_waitcnt lgkmcnt(4)
v_mfma_f32_32x32x16_bf16 v[64:79], a[120:123], v[120:123], v[64:79]
ds_read_b128 v[108:111], v2 offset:31744
s_waitcnt lgkmcnt(4)
v_mfma_f32_32x32x16_bf16 v[64:79], a[124:127], v[124:127], v[64:79]
ds_read_b128 v[112:115], v2 offset:57344
s_waitcnt lgkmcnt(4)
v_mfma_f32_32x32x16_bf16 v[64:79], a[128:131], v[96:99], v[64:79]
ds_read_b128 v[116:119], v2 offset:58368
s_waitcnt lgkmcnt(4)
v_mfma_f32_32x32x16_bf16 v[64:79], a[132:135], v[100:103], v[64:79]
ds_read_b128 v[120:123], v2 offset:59392
s_waitcnt lgkmcnt(4)
v_mfma_f32_32x32x16_bf16 v[64:79], a[136:139], v[104:107], v[64:79]
ds_read_b128 v[124:127], v2 offset:60416
s_waitcnt lgkmcnt(4)
v_mfma_f32_32x32x16_bf16 v[64:79], a[140:143], v[108:111], v[64:79]
s_waitcnt vmcnt(14)
s_barrier
ds_read_b128 v[96:99], v2 offset:61440
s_waitcnt lgkmcnt(4)
v_mfma_f32_32x32x16_bf16 v[64:79], a[144:147], v[112:115], v[64:79]
ds_read_b128 v[100:103], v2 offset:62464
s_waitcnt lgkmcnt(4)
v_mfma_f32_32x32x16_bf16 v[64:79], a[148:151], v[116:119], v[64:79]
buffer_load_dwordx4 v[208:211], v2, s[52:55], s25 offen offset:0 sc1
ds_read_b128 v[104:107], v2 offset:63488
s_waitcnt lgkmcnt(4)
v_mfma_f32_32x32x16_bf16 v[64:79], a[152:155], v[120:123], v[64:79]
buffer_load_dwordx4 v[212:215], v2, s[52:55], s25 offen offset:1024 sc1
ds_read_b128 v[108:111], v2 offset:64512
s_waitcnt lgkmcnt(4)
v_mfma_f32_32x32x16_bf16 v[64:79], a[156:159], v[124:127], v[64:79]
buffer_load_dwordx4 v[216:219], v2, s[52:55], s25 offen offset:2048 sc1
ds_read_b128 v[112:115], v13 offset:0
s_waitcnt lgkmcnt(4)
v_mfma_f32_32x32x16_bf16 v[64:79], a[160:163], v[96:99], v[64:79]
buffer_load_dwordx4 v[220:223], v2, s[52:55], s25 offen offset:3072 sc1
ds_read_b128 v[116:119], v13 offset:1024
s_waitcnt lgkmcnt(4)
v_mfma_f32_32x32x16_bf16 v[64:79], a[164:167], v[100:103], v[64:79]
ds_read_b128 v[120:123], v13 offset:2048
s_waitcnt lgkmcnt(4)
v_mfma_f32_32x32x16_bf16 v[64:79], a[168:171], v[104:107], v[64:79]
ds_read_b128 v[124:127], v13 offset:3072
s_waitcnt lgkmcnt(4)
v_mfma_f32_32x32x16_bf16 v[64:79], a[172:175], v[108:111], v[64:79]
s_waitcnt vmcnt(12)
s_barrier
ds_read_b128 v[96:99], v13 offset:4096
s_waitcnt lgkmcnt(4)
v_mfma_f32_32x32x16_bf16 v[64:79], a[176:179], v[112:115], v[64:79]
ds_read_b128 v[100:103], v13 offset:5120
s_waitcnt lgkmcnt(4)
v_mfma_f32_32x32x16_bf16 v[64:79], a[180:183], v[116:119], v[64:79]
buffer_load_dwordx4 v[224:227], v2, s[52:55], s26 offen offset:0 sc1
ds_read_b128 v[104:107], v13 offset:6144
s_waitcnt lgkmcnt(4)
v_mfma_f32_32x32x16_bf16 v[64:79], a[184:187], v[120:123], v[64:79]
buffer_load_dwordx4 v[228:231], v2, s[52:55], s26 offen offset:1024 sc1
ds_read_b128 v[108:111], v13 offset:7168
s_waitcnt lgkmcnt(4)
v_mfma_f32_32x32x16_bf16 v[64:79], a[188:191], v[124:127], v[64:79]
buffer_load_dwordx4 v[232:235], v2, s[52:55], s26 offen offset:2048 sc1
ds_read_b128 v[112:115], v13 offset:8192
s_waitcnt lgkmcnt(4)
v_mfma_f32_32x32x16_bf16 v[64:79], a[192:195], v[96:99], v[64:79]
buffer_load_dwordx4 v[236:239], v2, s[52:55], s26 offen offset:3072 sc1
ds_read_b128 v[116:119], v13 offset:9216
s_waitcnt lgkmcnt(4)
v_mfma_f32_32x32x16_bf16 v[64:79], a[196:199], v[100:103], v[64:79]
ds_read_b128 v[120:123], v13 offset:10240
s_waitcnt lgkmcnt(4)
v_mfma_f32_32x32x16_bf16 v[64:79], a[200:203], v[104:107], v[64:79]
ds_read_b128 v[124:127], v13 offset:11264
s_waitcnt lgkmcnt(4)
v_mfma_f32_32x32x16_bf16 v[64:79], a[204:207], v[108:111], v[64:79]
s_waitcnt lgkmcnt(3)
v_mfma_f32_32x32x16_bf16 v[64:79], a[208:211], v[112:115], v[64:79]
s_waitcnt lgkmcnt(2)
v_mfma_f32_32x32x16_bf16 v[64:79], a[212:215], v[116:119], v[64:79]
s_waitcnt lgkmcnt(1)
v_mfma_f32_32x32x16_bf16 v[64:79], a[216:219], v[120:123], v[64:79]
s_waitcnt lgkmcnt(0)
v_mfma_f32_32x32x16_bf16 v[64:79], a[220:223], v[124:127], v[64:79]
s_mov_b32 s63, 100000
s_waitcnt vmcnt(12)
L_chk0:
v_xor_b32 v176, v192, v12
v_xor_b32 v177, v193, v12
v_xor_b32 v178, v194, v12
v_xor_b32 v179, v195, v12
v_xor_b32 v180, v196, v12
v_xor_b32 v181, v197, v12
v_xor_b32 v182, v198, v12
v_xor_b32 v183, v199, v12
v_xor_b32 v184, v200, v12
v_xor_b32 v185, v201, v12
v_xor_b32 v186, v202, v12
v_xor_b32 v187, v203, v12
v_xor_b32 v188, v204, v12
v_xor_b32 v189, v205, v12
v_xor_b32 v190, v206, v12
v_xor_b32 v191, v207, v12
v_or3_b32 v10, v176, v177, v178
v_or3_b32 v11, v179, v180, v181
v_or3_b32 v10, v10, v182, v183
v_or3_b32 v11, v11, v184, v185
v_or3_b32 v10, v10, v186, v187
v_or3_b32 v11, v11, v188, v189
v_or3_b32 v10, v10, v190, v191
v_or_b32 v10, v10, v11
v_and_b32 v10, 0xff, v10
v_cmp_ne_u32 vcc, 0, v10
s_cbranch_vccz L_chk0_x
s_sub_u32 s63, s63, 1
s_cbranch_scc1 L_chk0_x
buffer_load_dwordx4 v[192:195], v2, s[52:55], s24 offen offset:0 sc1
buffer_load_dwordx4 v[196:199], v2, s[52:55], s24 offen offset:1024 sc1
buffer_load_dwordx4 v[200:203], v2, s[52:55], s24 offen offset:2048 sc1
buffer_load_dwordx4 v[204:207], v2, s[52:55], s24 offen offset:3072 sc1
s_waitcnt vmcnt(0)
s_branch L_chk0
L_chk0_x:
.p2align 3
v_pk_add_f32 v[64:65], v[64:65], v[176:177]
v_pk_add_f32 v[66:67], v[66:67], v[178:179]
v_pk_add_f32 v[68:69], v[68:69], v[180:181]
v_pk_add_f32 v[70:71], v[70:71], v[182:183]
v_pk_add_f32 v[72:73], v[72:73], v[184:185]
v_pk_add_f32 v[74:75], v[74:75], v[186:187]
v_pk_add_f32 v[76:77], v[76:77], v[188:189]
v_pk_add_f32 v[78:79], v[78:79], v[190:191]
s_mov_b32 s63, 100000
s_waitcnt vmcnt(4)
L_chk1:
v_xor_b32 v176, v208, v12
v_xor_b32 v177, v209, v12
v_xor_b32 v178, v210, v12
v_xor_b32 v179, v211, v12
v_xor_b32 v180, v212, v12
v_xor_b32 v181, v213, v12
v_xor_b32 v182, v214, v12
v_xor_b32 v183, v215, v12
v_xor_b32 v184, v216, v12
v_xor_b32 v185, v217, v12
v_xor_b32 v186, v218, v12
v_xor_b32 v187, v219, v12
v_xor_b32 v188, v220, v12
v_xor_b32 v189, v221, v12
v_xor_b32 v190, v222, v12
v_xor_b32 v191, v223, v12
v_or3_b32 v10, v176, v177, v178
v_or3_b32 v11, v179, v180, v181
v_or3_b32 v10, v10, v182, v183
v_or3_b32 v11, v11, v184, v185
v_or3_b32 v10, v10, v186, v187
v_or3_b32 v11, v11, v188, v189
v_or3_b32 v10, v10, v190, v191
v_or_b32 v10, v10, v11
v_and_b32 v10, 0xff, v10
v_cmp_ne_u32 vcc, 0, v10
s_cbranch_vccz L_chk1_x
s_sub_u32 s63, s63, 1
s_cbranch_scc1 L_chk1_x
buffer_load_dwordx4 v[208:211], v2, s[52:55], s25 offen offset:0 sc1
buffer_load_dwordx4 v[212:215], v2, s[52:55], s25 offen offset:1024 sc1
buffer_load_dwordx4 v[216:219], v2, s[52:55], s25 offen offset:2048 sc1
buffer_load_dwordx4 v[220:223], v2, s[52:55], s25 offen offset:3072 sc1
s_waitcnt vmcnt(0)
s_branch L_chk1
L_chk1_x:
.p2align 3
v_pk_add_f32 v[64:65], v[64:65], v[176:177]
v_pk_add_f32 v[66:67], v[66:67], v[178:179]
v_pk_add_f32 v[68:69], v[68:69], v[180:181]
v_pk_add_f32 v[70:71], v[70:71], v[182:183]
v_pk_add_f32 v[72:73], v[72:73], v[184:185]
v_pk_add_f32 v[74:75], v[74:75], v[186:187]
v_pk_add_f32 v[76:77], v[76:77], v[188:189]
v_pk_add_f32 v[78:79], v[78:79], v[190:191]
s_mov_b32 s63, 100000
s_waitcnt vmcnt(0)
L_chk2:
v_xor_b32 v176, v224, v12
v_xor_b32 v177, v225, v12
v_xor_b32 v178, v226, v12
v_xor_b32 v179, v227, v12
v_xor_b32 v180, v228, v12
v_xor_b32 v181, v229, v12
v_xor_b32 v182, v230, v12
v_xor_b32 v183, v231, v12
v_xor_b32 v184, v232, v12
v_xor_b32 v185, v233, v12
v_xor_b32 v186, v234, v12
v_xor_b32 v187, v235, v12
v_xor_b32 v188, v236, v12
v_xor_b32 v189, v237, v12
v_xor_b32 v190, v238, v12
v_xor_b32 v191, v239, v12
v_or3_b32 v10, v176, v177, v178
v_or3_b32 v11, v179, v180, v181
v_or3_b32 v10, v10, v182, v183
v_or3_b32 v11, v11, v184, v185
v_or3_b32 v10, v10, v186, v187
v_or3_b32 v11, v11, v188, v189
v_or3_b32 v10, v10, v190, v191
v_or_b32 v10, v10, v11
v_and_b32 v10, 0xff, v10
v_cmp_ne_u32 vcc, 0, v10
s_cbranch_vccz L_chk2_x
s_sub_u32 s63, s63, 1
s_cbranch_scc1 L_chk2_x
buffer_load_dwordx4 v[224:227], v2, s[52:55], s26 offen offset:0 sc1
buffer_load_dwordx4 v[228:231], v2, s[52:55], s26 offen offset:1024 sc1
buffer_load_dwordx4 v[232:235], v2, s[52:55], s26 offen offset:2048 sc1
buffer_load_dwordx4 v[236:239], v2, s[52:55], s26 offen offset:3072 sc1
s_waitcnt vmcnt(0)
s_branch L_chk2
L_chk2_x:
.p2align 3
v_pk_add_f32 v[64:65], v[64:65], v[176:177]
v_pk_add_f32 v[66:67], v[66:67], v[178:179]
v_pk_add_f32 v[68:69], v[68:69], v[180:181]
v_pk_add_f32 v[70:71], v[70:71], v[182:183]
v_pk_add_f32 v[72:73], v[72:73], v[184:185]
v_pk_add_f32 v[74:75], v[74:75], v[186:187]
v_pk_add_f32 v[76:77], v[76:77], v[188:189]
v_pk_add_f32 v[78:79], v[78:79], v[190:191]
v_cvt_pk_bf16_f32 v96, v64, v65
v_cvt_pk_bf16_f32 v97, v66, v67
v_cvt_pk_bf16_f32 v98, v68, v69
v_cvt_pk_bf16_f32 v99, v70, v71
v_cvt_pk_bf16_f32 v100, v72, v73
v_cvt_pk_bf16_f32 v101, v74, v75
v_cvt_pk_bf16_f32 v102, v76, v77
v_cvt_pk_bf16_f32 v103, v78, v79
s_nop 1
v_permlane32_swap_b32 v96, v98
v_permlane32_swap_b32 v97, v99
v_permlane32_swap_b32 v100, v102
v_permlane32_swap_b32 v101, v103
buffer_store_dwordx4 v[96:99], v9, s[48:51], s23 offen
buffer_store_dwordx4 v[100:103], v9, s[48:51], s23 offen offset:32
s_lshr_b32 s61, s57, 1
s_or_b32 s61, s61, s56
s_or_b32 s61, s61, s3
s_cmp_lg_u32 s61, 0
s_cbranch_scc1 L_noep
s_lshl_b32 s61, s64, 7
s_add_u32 s61, s61, 3145728
s_mov_b64 exec, 1
buffer_store_dword v7, v0, s[52:55], s61 offen sc1
s_mov_b64 exec, -1
L_noep:
s_branch L_fin
L_g1:
s_and_b32 s64, s56, 1
s_lshr_b32 s59, s56, 1
s_lshl_b32 s59, s59, 2
s_add_u32 s59, s59, s57
s_sub_u32 s59, s59, 28
v_lshrrev_b32 v11, 3, v1
v_and_b32 v12, 7, v1
v_and_b32 v13, 2, v11
v_xor_b32 v13, v12, v13
v_lshlrev_b32 v14, 11, v11
v_lshl_add_u32 v9, v13, 4, v14
v_xor_b32 v10, 64, v9
v_lshrrev_b32 v13, 1, v11
v_xor_b32 v13, v12, v13
v_lshl_add_u32 v8, v13, 4, v14
v_xor_b32 v11, 64, v8
s_lshl_b32 s58, s3, 15
s_lshl_b32 s62, s59, 7
s_add_u32 s58, s58, s62
s_lshl_b32 s65, s64, 2
s_add_u32 s65, s65, s3
s_lshl_b32 s65, s65, 16
s_waitcnt lgkmcnt(0)
s_mov_b32 s24, s4
s_mov_b32 s25, s5
s_mov_b32 s26, 524288
s_mov_b32 s27, 0x20000
s_mov_b32 s40, s12
s_mov_b32 s41, s13
s_mov_b32 s42, 2097152
s_mov_b32 s43, 0x20000
s_lshl_b32 s4, s3, 11
s_lshl_b32 s5, s3, 12
s_add_u32 s5, s5, 8192
s_add_u32 m0, s4, 0
s_add_u32 s62, s58, 0
buffer_load_dwordx4 v9, s[40:43], s62 offen lds
s_add_u32 m0, s4, 1024
s_add_u32 s62, s58, 16384
buffer_load_dwordx4 v10, s[40:43], s62 offen lds
s_add_u32 m0, s5, 0
s_add_u32 s62, s65, 0
buffer_load_dwordx4 v8, s[24:27], s62 offen lds
s_add_u32 m0, s5, 1024
s_add_u32 s62, s65, 16384
buffer_load_dwordx4 v11, s[24:27], s62 offen lds
s_add_u32 m0, s5, 2048
s_add_u32 s62, s65, 32768
buffer_load_dwordx4 v8, s[24:27], s62 offen lds
s_add_u32 m0, s5, 3072
s_add_u32 s62, s65, 49152
buffer_load_dwordx4 v11, s[24:27], s62 offen lds
s_add_u32 m0, s4, 24576
s_add_u32 s62, s58, 131072
buffer_load_dwordx4 v9, s[40:43], s62 offen lds
s_add_u32 m0, s4, 25600
s_add_u32 s62, s58, 147456
buffer_load_dwordx4 v10, s[40:43], s62 offen lds
s_add_u32 m0, s5, 24576
s_add_u32 s62, s65, 128
buffer_load_dwordx4 v8, s[24:27], s62 offen lds
s_add_u32 m0, s5, 25600
s_add_u32 s62, s65, 16512
buffer_load_dwordx4 v11, s[24:27], s62 offen lds
s_add_u32 m0, s5, 26624
s_add_u32 s62, s65, 32896
buffer_load_dwordx4 v8, s[24:27], s62 offen lds
s_add_u32 m0, s5, 27648
s_add_u32 s62, s65, 49280
buffer_load_dwordx4 v11, s[24:27], s62 offen lds
s_add_u32 m0, s4, 49152
s_add_u32 s62, s58, 262144
buffer_load_dwordx4 v9, s[40:43], s62 offen lds
s_add_u32 m0, s4, 50176
s_add_u32 s62, s58, 278528
buffer_load_dwordx4 v10, s[40:43], s62 offen lds
s_add_u32 m0, s5, 49152
s_add_u32 s62, s65, 256
buffer_load_dwordx4 v8, s[24:27], s62 offen lds
s_add_u32 m0, s5, 50176
s_add_u32 s62, s65, 16640
buffer_load_dwordx4 v11, s[24:27], s62 offen lds
s_add_u32 m0, s5, 51200
s_add_u32 s62, s65, 33024
buffer_load_dwordx4 v8, s[24:27], s62 offen lds
s_add_u32 m0, s5, 52224
s_add_u32 s62, s65, 49408
buffer_load_dwordx4 v11, s[24:27], s62 offen lds
s_lshl_b32 s61, s64, 7
s_add_u32 s61, s61, 3145728
s_add_u32 s22, s20, s61
s_addc_u32 s23, s21, 0
s_load_dword s60, s[22:23], 0
s_mov_b32 s44, s14
s_mov_b32 s45, s15
s_mov_b32 s46, 25690112
s_mov_b32 s47, 0x20000
s_mov_b32 s52, s20
s_mov_b32 s53, s21
s_mov_b32 s54, 268435456
s_mov_b32 s55, 0x20000
v_lshrrev_b32 v50, 2, v3
v_and_b32 v51, 3, v3
v_lshlrev_b32 v52, 10, v4
v_lshl_add_u32 v52, v50, 7, v52
v_lshl_add_u32 v52, v51, 3, v52
v_lshrrev_b32 v53, 1, v50
v_and_b32 v51, 1, v4
v_lshl_add_u32 v53, v51, 1, v53
v_lshlrev_b32 v53, 5, v53
v_xor_b32 v16, 0, v53
v_add_u32 v16, v16, v52
v_add_u32 v17, 49152, v16
v_add_u32 v18, 98304, v16
v_xor_b32 v19, 32, v53
v_add_u32 v19, v19, v52
v_add_u32 v20, 49152, v19
v_add_u32 v21, 98304, v19
v_xor_b32 v22, 64, v53
v_add_u32 v22, v22, v52
v_add_u32 v23, 49152, v22
v_add_u32 v24, 98304, v22
v_xor_b32 v25, 96, v53
v_add_u32 v25, v25, v52
v_add_u32 v26, 49152, v25
v_add_u32 v27, 98304, v25
v_lshrrev_b32 v50, 1, v3
v_xor_b32 v50, v50, v4
v_lshlrev_b32 v50, 4, v50
v_lshl_add_u32 v50, v3, 7, v50
v_add_u32 v28, s5, v50
v_xor_b32 v50, 64, v50
v_add_u32 v31, s5, v50
v_add_u32 v29, 49152, v28
v_add_u32 v30, 98304, v28
v_add_u32 v32, 49152, v31
v_add_u32 v33, 98304, v31
s_waitcnt lgkmcnt(0)
s_add_u32 s60, s60, 2654435769
s_waitcnt vmcnt(12)
s_barrier
ds_read_b128 v[96:99], v28 offset:0
ds_read_b128 v[100:103], v28 offset:2048
ds_read_b64_tr_b16 v[112:113], v16 offset:0
ds_read_b64_tr_b16 v[114:115], v16 offset:512
ds_read_b64_tr_b16 v[116:117], v19 offset:0
ds_read_b64_tr_b16 v[118:119], v19 offset:512
ds_read_b64_tr_b16 v[120:121], v22 offset:0
ds_read_b64_tr_b16 v[122:123], v22 offset:512
ds_read_b64_tr_b16 v[124:125], v25 offset:0
ds_read_b64_tr_b16 v[126:127], v25 offset:512
s_waitcnt lgkmcnt(0)
v_mfma_f32_16x16x32_bf16 v[64:67], v[112:115], v[96:99], 0
ds_read_b128 v[104:107], v31 offset:0
ds_read_b128 v[108:111], v31 offset:2048
v_mfma_f32_16x16x32_bf16 v[80:83], v[112:115], v[100:103], 0
ds_read_b64_tr_b16 v[128:129], v16 offset:4096
ds_read_b64_tr_b16 v[130:131], v16 offset:4608
v_mfma_f32_16x16x32_bf16 v[68:71], v[116:119], v[96:99], 0
ds_read_b64_tr_b16 v[132:133], v19 offset:4096
ds_read_b64_tr_b16 v[134:135], v19 offset:4608
v_mfma_f32_16x16x32_bf16 v[84:87], v[116:119], v[100:103], 0
ds_read_b64_tr_b16 v[136:137], v22 offset:4096
ds_read_b64_tr_b16 v[138:139], v22 offset:4608
v_mfma_f32_16x16x32_bf16 v[72:75], v[120:123], v[96:99], 0
ds_read_b64_tr_b16 v[140:141], v25 offset:4096
ds_read_b64_tr_b16 v[142:143], v25 offset:4608
v_mfma_f32_16x16x32_bf16 v[88:91], v[120:123], v[100:103], 0
s_add_u32 m0, s4, 73728
s_add_u32 s62, s58, 393216
buffer_load_dwordx4 v9, s[40:43], s62 offen lds
v_mfma_f32_16x16x32_bf16 v[76:79], v[124:127], v[96:99], 0
s_add_u32 m0, s4, 74752
s_add_u32 s62, s58, 409600
buffer_load_dwordx4 v10, s[40:43], s62 offen lds
v_mfma_f32_16x16x32_bf16 v[92:95], v[124:127], v[100:103], 0
s_add_u32 m0, s5, 73728
s_add_u32 s62, s65, 384
buffer_load_dwordx4 v8, s[24:27], s62 offen lds
s_waitcnt vmcnt(9)
s_barrier
s_waitcnt lgkmcnt(0)
v_mfma_f32_16x16x32_bf16 v[64:67], v[128:131], v[104:107], v[64:67]
ds_read_b128 v[96:99], v28 offset:24576
ds_read_b128 v[100:103], v28 offset:26624
v_mfma_f32_16x16x32_bf16 v[80:83], v[128:131], v[108:111], v[80:83]
ds_read_b64_tr_b16 v[112:113], v16 offset:24576
ds_read_b64_tr_b16 v[114:115], v16 offset:25088
v_mfma_f32_16x16x32_bf16 v[68:71], v[132:135], v[104:107], v[68:71]
ds_read_b64_tr_b16 v[116:117], v19 offset:24576
ds_read_b64_tr_b16 v[118:119], v19 offset:25088
v_mfma_f32_16x16x32_bf16 v[84:87], v[132:135], v[108:111], v[84:87]
ds_read_b64_tr_b16 v[120:121], v22 offset:24576
ds_read_b64_tr_b16 v[122:123], v22 offset:25088
v_mfma_f32_16x16x32_bf16 v[72:75], v[136:139], v[104:107], v[72:75]
ds_read_b64_tr_b16 v[124:125], v25 offset:24576
ds_read_b64_tr_b16 v[126:127], v25 offset:25088
v_mfma_f32_16x16x32_bf16 v[88:91], v[136:139], v[108:111], v[88:91]
s_add_u32 m0, s5, 74752
s_add_u32 s62, s65, 16768
buffer_load_dwordx4 v11, s[24:27], s62 offen lds
v_mfma_f32_16x16x32_bf16 v[76:79], v[140:143], v[104:107], v[76:79]
s_add_u32 m0, s5, 75776
s_add_u32 s62, s65, 33152
buffer_load_dwordx4 v8, s[24:27], s62 offen lds
v_mfma_f32_16x16x32_bf16 v[92:95], v[140:143], v[108:111], v[92:95]
s_add_u32 m0, s5, 76800
s_add_u32 s62, s65, 49536
buffer_load_dwordx4 v11, s[24:27], s62 offen lds
s_waitcnt lgkmcnt(0)
v_mfma_f32_16x16x32_bf16 v[64:67], v[112:115], v[96:99], v[64:67]
ds_read_b128 v[104:107], v31 offset:24576
ds_read_b128 v[108:111], v31 offset:26624
v_mfma_f32_16x16x32_bf16 v[80:83], v[112:115], v[100:103], v[80:83]
ds_read_b64_tr_b16 v[128:129], v16 offset:28672
ds_read_b64_tr_b16 v[130:131], v16 offset:29184
v_mfma_f32_16x16x32_bf16 v[68:71], v[116:119], v[96:99], v[68:71]
ds_read_b64_tr_b16 v[132:133], v19 offset:28672
ds_read_b64_tr_b16 v[134:135], v19 offset:29184
v_mfma_f32_16x16x32_bf16 v[84:87], v[116:119], v[100:103], v[84:87]
ds_read_b64_tr_b16 v[136:137], v22 offset:28672
ds_read_b64_tr_b16 v[138:139], v22 offset:29184
v_mfma_f32_16x16x32_bf16 v[72:75], v[120:123], v[96:99], v[72:75]
ds_read_b64_tr_b16 v[140:141], v25 offset:28672
ds_read_b64_tr_b16 v[142:143], v25 offset:29184
v_mfma_f32_16x16x32_bf16 v[88:91], v[120:123], v[100:103], v[88:91]
s_add_u32 m0, s4, 98304
s_add_u32 s62, s58, 524288
buffer_load_dwordx4 v9, s[40:43], s62 offen lds
v_mfma_f32_16x16x32_bf16 v[76:79], v[124:127], v[96:99], v[76:79]
s_add_u32 m0, s4, 99328
s_add_u32 s62, s58, 540672
buffer_load_dwordx4 v10, s[40:43], s62 offen lds
v_mfma_f32_16x16x32_bf16 v[92:95], v[124:127], v[100:103], v[92:95]
s_add_u32 m0, s5, 98304
s_add_u32 s62, s65, 512
buffer_load_dwordx4 v8, s[24:27], s62 offen lds
s_waitcnt vmcnt(9)
s_barrier
s_waitcnt lgkmcnt(0)
v_mfma_f32_16x16x32_bf16 v[64:67], v[128:131], v[104:107], v[64:67]
ds_read_b128 v[96:99], v29 offset:0
ds_read_b128 v[100:103], v29 offset:2048
v_mfma_f32_16x16x32_bf16 v[80:83], v[128:131], v[108:111], v[80:83]
ds_read_b64_tr_b16 v[112:113], v17 offset:0
ds_read_b64_tr_b16 v[114:115], v17 offset:512
v_mfma_f32_16x16x32_bf16 v[68:71], v[132:135], v[104:107], v[68:71]
ds_read_b64_tr_b16 v[116:117], v20 offset:0
ds_read_b64_tr_b16 v[118:119], v20 offset:512
v_mfma_f32_16x16x32_bf16 v[84:87], v[132:135], v[108:111], v[84:87]
ds_read_b64_tr_b16 v[120:121], v23 offset:0
ds_read_b64_tr_b16 v[122:123], v23 offset:512
v_mfma_f32_16x16x32_bf16 v[72:75], v[136:139], v[104:107], v[72:75]
ds_read_b64_tr_b16 v[124:125], v26 offset:0
ds_read_b64_tr_b16 v[126:127], v26 offset:512
v_mfma_f32_16x16x32_bf16 v[88:91], v[136:139], v[108:111], v[88:91]
s_add_u32 m0, s5, 99328
s_add_u32 s62, s65, 16896
buffer_load_dwordx4 v11, s[24:27], s62 offen lds
v_mfma_f32_16x16x32_bf16 v[76:79], v[140:143], v[104:107], v[76:79]
s_add_u32 m0, s5, 100352
s_add_u32 s62, s65, 33280
buffer_load_dwordx4 v8, s[24:27], s62 offen lds
v_mfma_f32_16x16x32_bf16 v[92:95], v[140:143], v[108:111], v[92:95]
s_add_u32 m0, s5, 101376
s_add_u32 s62, s65, 49664
buffer_load_dwordx4 v11, s[24:27], s62 offen lds
s_waitcnt lgkmcnt(0)
v_mfma_f32_16x16x32_bf16 v[64:67], v[112:115], v[96:99], v[64:67]
ds_read_b128 v[104:107], v32 offset:0
ds_read_b128 v[108:111], v32 offset:2048
v_mfma_f32_16x16x32_bf16 v[80:83], v[112:115], v[100:103], v[80:83]
ds_read_b64_tr_b16 v[128:129], v17 offset:4096
ds_read_b64_tr_b16 v[130:131], v17 offset:4608
v_mfma_f32_16x16x32_bf16 v[68:71], v[116:119], v[96:99], v[68:71]
ds_read_b64_tr_b16 v[132:133], v20 offset:4096
ds_read_b64_tr_b16 v[134:135], v20 offset:4608
v_mfma_f32_16x16x32_bf16 v[84:87], v[116:119], v[100:103], v[84:87]
ds_read_b64_tr_b16 v[136:137], v23 offset:4096
ds_read_b64_tr_b16 v[138:139], v23 offset:4608
v_mfma_f32_16x16x32_bf16 v[72:75], v[120:123], v[96:99], v[72:75]
ds_read_b64_tr_b16 v[140:141], v26 offset:4096
ds_read_b64_tr_b16 v[142:143], v26 offset:4608
v_mfma_f32_16x16x32_bf16 v[88:91], v[120:123], v[100:103], v[88:91]
s_add_u32 m0, s4, 122880
s_add_u32 s62, s58, 655360
buffer_load_dwordx4 v9, s[40:43], s62 offen lds
v_mfma_f32_16x16x32_bf16 v[76:79], v[124:127], v[96:99], v[76:79]
s_add_u32 m0, s4, 123904
s_add_u32 s62, s58, 671744
buffer_load_dwordx4 v10, s[40:43], s62 offen lds
v_mfma_f32_16x16x32_bf16 v[92:95], v[124:127], v[100:103], v[92:95]
s_add_u32 m0, s5, 122880
s_add_u32 s62, s65, 640
buffer_load_dwordx4 v8, s[24:27], s62 offen lds
s_waitcnt vmcnt(9)
s_barrier
s_waitcnt lgkmcnt(0)
v_mfma_f32_16x16x32_bf16 v[64:67], v[128:131], v[104:107], v[64:67]
ds_read_b128 v[96:99], v29 offset:24576
ds_read_b128 v[100:103], v29 offset:26624
v_mfma_f32_16x16x32_bf16 v[80:83], v[128:131], v[108:111], v[80:83]
ds_read_b64_tr_b16 v[112:113], v17 offset:24576
ds_read_b64_tr_b16 v[114:115], v17 offset:25088
v_mfma_f32_16x16x32_bf16 v[68:71], v[132:135], v[104:107], v[68:71]
ds_read_b64_tr_b16 v[116:117], v20 offset:24576
ds_read_b64_tr_b16 v[118:119], v20 offset:25088
v_mfma_f32_16x16x32_bf16 v[84:87], v[132:135], v[108:111], v[84:87]
ds_read_b64_tr_b16 v[120:121], v23 offset:24576
ds_read_b64_tr_b16 v[122:123], v23 offset:25088
v_mfma_f32_16x16x32_bf16 v[72:75], v[136:139], v[104:107], v[72:75]
ds_read_b64_tr_b16 v[124:125], v26 offset:24576
ds_read_b64_tr_b16 v[126:127], v26 offset:25088
v_mfma_f32_16x16x32_bf16 v[88:91], v[136:139], v[108:111], v[88:91]
s_add_u32 m0, s5, 123904
s_add_u32 s62, s65, 17024
buffer_load_dwordx4 v11, s[24:27], s62 offen lds
v_mfma_f32_16x16x32_bf16 v[76:79], v[140:143], v[104:107], v[76:79]
s_add_u32 m0, s5, 124928
s_add_u32 s62, s65, 33408
buffer_load_dwordx4 v8, s[24:27], s62 offen lds
v_mfma_f32_16x16x32_bf16 v[92:95], v[140:143], v[108:111], v[92:95]
s_add_u32 m0, s5, 125952
s_add_u32 s62, s65, 49792
buffer_load_dwordx4 v11, s[24:27], s62 offen lds
s_waitcnt lgkmcnt(0)
v_mfma_f32_16x16x32_bf16 v[64:67], v[112:115], v[96:99], v[64:67]
ds_read_b128 v[104:107], v32 offset:24576
ds_read_b128 v[108:111], v32 offset:26624
v_mfma_f32_16x16x32_bf16 v[80:83], v[112:115], v[100:103], v[80:83]
ds_read_b64_tr_b16 v[128:129], v17 offset:28672
ds_read_b64_tr_b16 v[130:131], v17 offset:29184
v_mfma_f32_16x16x32_bf16 v[68:71], v[116:119], v[96:99], v[68:71]
ds_read_b64_tr_b16 v[132:133], v20 offset:28672
ds_read_b64_tr_b16 v[134:135], v20 offset:29184
v_mfma_f32_16x16x32_bf16 v[84:87], v[116:119], v[100:103], v[84:87]
ds_read_b64_tr_b16 v[136:137], v23 offset:28672
ds_read_b64_tr_b16 v[138:139], v23 offset:29184
v_mfma_f32_16x16x32_bf16 v[72:75], v[120:123], v[96:99], v[72:75]
ds_read_b64_tr_b16 v[140:141], v26 offset:28672
ds_read_b64_tr_b16 v[142:143], v26 offset:29184
v_mfma_f32_16x16x32_bf16 v[88:91], v[120:123], v[100:103], v[88:91]
s_add_u32 m0, s4, 0
s_add_u32 s62, s58, 786432
buffer_load_dwordx4 v9, s[40:43], s62 offen lds
v_mfma_f32_16x16x32_bf16 v[76:79], v[124:127], v[96:99], v[76:79]
s_add_u32 m0, s4, 1024
s_add_u32 s62, s58, 802816
buffer_load_dwordx4 v10, s[40:43], s62 offen lds
v_mfma_f32_16x16x32_bf16 v[92:95], v[124:127], v[100:103], v[92:95]
s_add_u32 m0, s5, 0
s_add_u32 s62, s65, 768
buffer_load_dwordx4 v8, s[24:27], s62 offen lds
s_waitcnt vmcnt(9)
s_barrier
s_waitcnt lgkmcnt(0)
v_mfma_f32_16x16x32_bf16 v[64:67], v[128:131], v[104:107], v[64:67]
ds_read_b128 v[96:99], v30 offset:0
ds_read_b128 v[100:103], v30 offset:2048
v_mfma_f32_16x16x32_bf16 v[80:83], v[128:131], v[108:111], v[80:83]
ds_read_b64_tr_b16 v[112:113], v18 offset:0
ds_read_b64_tr_b16 v[114:115], v18 offset:512
v_mfma_f32_16x16x32_bf16 v[68:71], v[132:135], v[104:107], v[68:71]
ds_read_b64_tr_b16 v[116:117], v21 offset:0
ds_read_b64_tr_b16 v[118:119], v21 offset:512
v_mfma_f32_16x16x32_bf16 v[84:87], v[132:135], v[108:111], v[84:87]
ds_read_b64_tr_b16 v[120:121], v24 offset:0
ds_read_b64_tr_b16 v[122:123], v24 offset:512
v_mfma_f32_16x16x32_bf16 v[72:75], v[136:139], v[104:107], v[72:75]
ds_read_b64_tr_b16 v[124:125], v27 offset:0
ds_read_b64_tr_b16 v[126:127], v27 offset:512
v_mfma_f32_16x16x32_bf16 v[88:91], v[136:139], v[108:111], v[88:91]
s_add_u32 m0, s5, 1024
s_add_u32 s62, s65, 17152
buffer_load_dwordx4 v11, s[24:27], s62 offen lds
v_mfma_f32_16x16x32_bf16 v[76:79], v[140:143], v[104:107], v[76:79]
s_add_u32 m0, s5, 2048
s_add_u32 s62, s65, 33536
buffer_load_dwordx4 v8, s[24:27], s62 offen lds
v_mfma_f32_16x16x32_bf16 v[92:95], v[140:143], v[108:111], v[92:95]
s_add_u32 m0, s5, 3072
s_add_u32 s62, s65, 49920
buffer_load_dwordx4 v11, s[24:27], s62 offen lds
s_waitcnt lgkmcnt(0)
v_mfma_f32_16x16x32_bf16 v[64:67], v[112:115], v[96:99], v[64:67]
ds_read_b128 v[104:107], v33 offset:0
ds_read_b128 v[108:111], v33 offset:2048
v_mfma_f32_16x16x32_bf16 v[80:83], v[112:115], v[100:103], v[80:83]
ds_read_b64_tr_b16 v[128:129], v18 offset:4096
ds_read_b64_tr_b16 v[130:131], v18 offset:4608
v_mfma_f32_16x16x32_bf16 v[68:71], v[116:119], v[96:99], v[68:71]
ds_read_b64_tr_b16 v[132:133], v21 offset:4096
ds_read_b64_tr_b16 v[134:135], v21 offset:4608
v_mfma_f32_16x16x32_bf16 v[84:87], v[116:119], v[100:103], v[84:87]
ds_read_b64_tr_b16 v[136:137], v24 offset:4096
ds_read_b64_tr_b16 v[138:139], v24 offset:4608
v_mfma_f32_16x16x32_bf16 v[72:75], v[120:123], v[96:99], v[72:75]
ds_read_b64_tr_b16 v[140:141], v27 offset:4096
ds_read_b64_tr_b16 v[142:143], v27 offset:4608
v_mfma_f32_16x16x32_bf16 v[88:91], v[120:123], v[100:103], v[88:91]
s_add_u32 m0, s4, 24576
s_add_u32 s62, s58, 917504
buffer_load_dwordx4 v9, s[40:43], s62 offen lds
v_mfma_f32_16x16x32_bf16 v[76:79], v[124:127], v[96:99], v[76:79]
s_add_u32 m0, s4, 25600
s_add_u32 s62, s58, 933888
buffer_load_dwordx4 v10, s[40:43], s62 offen lds
v_mfma_f32_16x16x32_bf16 v[92:95], v[124:127], v[100:103], v[92:95]
s_add_u32 m0, s5, 24576
s_add_u32 s62, s65, 896
buffer_load_dwordx4 v8, s[24:27], s62 offen lds
s_waitcnt vmcnt(9)
s_barrier
s_waitcnt lgkmcnt(0)
v_mfma_f32_16x16x32_bf16 v[64:67], v[128:131], v[104:107], v[64:67]
ds_read_b128 v[96:99], v30 offset:24576
ds_read_b128 v[100:103], v30 offset:26624
v_mfma_f32_16x16x32_bf16 v[80:83], v[128:131], v[108:111], v[80:83]
ds_read_b64_tr_b16 v[112:113], v18 offset:24576
ds_read_b64_tr_b16 v[114:115], v18 offset:25088
v_mfma_f32_16x16x32_bf16 v[68:71], v[132:135], v[104:107], v[68:71]
ds_read_b64_tr_b16 v[116:117], v21 offset:24576
ds_read_b64_tr_b16 v[118:119], v21 offset:25088
v_mfma_f32_16x16x32_bf16 v[84:87], v[132:135], v[108:111], v[84:87]
ds_read_b64_tr_b16 v[120:121], v24 offset:24576
ds_read_b64_tr_b16 v[122:123], v24 offset:25088
v_mfma_f32_16x16x32_bf16 v[72:75], v[136:139], v[104:107], v[72:75]
ds_read_b64_tr_b16 v[124:125], v27 offset:24576
ds_read_b64_tr_b16 v[126:127], v27 offset:25088
v_mfma_f32_16x16x32_bf16 v[88:91], v[136:139], v[108:111], v[88:91]
s_add_u32 m0, s5, 25600
s_add_u32 s62, s65, 17280
buffer_load_dwordx4 v11, s[24:27], s62 offen lds
v_mfma_f32_16x16x32_bf16 v[76:79], v[140:143], v[104:107], v[76:79]
s_add_u32 m0, s5, 26624
s_add_u32 s62, s65, 33664
buffer_load_dwordx4 v8, s[24:27], s62 offen lds
v_mfma_f32_16x16x32_bf16 v[92:95], v[140:143], v[108:111], v[92:95]
s_add_u32 m0, s5, 27648
s_add_u32 s62, s65, 50048
buffer_load_dwordx4 v11, s[24:27], s62 offen lds
s_waitcnt lgkmcnt(0)
v_mfma_f32_16x16x32_bf16 v[64:67], v[112:115], v[96:99], v[64:67]
ds_read_b128 v[104:107], v33 offset:24576
ds_read_b128 v[108:111], v33 offset:26624
v_mfma_f32_16x16x32_bf16 v[80:83], v[112:115], v[100:103], v[80:83]
ds_read_b64_tr_b16 v[128:129], v18 offset:28672
ds_read_b64_tr_b16 v[130:131], v18 offset:29184
v_mfma_f32_16x16x32_bf16 v[68:71], v[116:119], v[96:99], v[68:71]
ds_read_b64_tr_b16 v[132:133], v21 offset:28672
ds_read_b64_tr_b16 v[134:135], v21 offset:29184
v_mfma_f32_16x16x32_bf16 v[84:87], v[116:119], v[100:103], v[84:87]
ds_read_b64_tr_b16 v[136:137], v24 offset:28672
ds_read_b64_tr_b16 v[138:139], v24 offset:29184
v_mfma_f32_16x16x32_bf16 v[72:75], v[120:123], v[96:99], v[72:75]
ds_read_b64_tr_b16 v[140:141], v27 offset:28672
ds_read_b64_tr_b16 v[142:143], v27 offset:29184
v_mfma_f32_16x16x32_bf16 v[88:91], v[120:123], v[100:103], v[88:91]
s_add_u32 m0, s4, 49152
s_add_u32 s62, s58, 1048576
buffer_load_dwordx4 v9, s[40:43], s62 offen lds
v_mfma_f32_16x16x32_bf16 v[76:79], v[124:127], v[96:99], v[76:79]
s_add_u32 m0, s4, 50176
s_add_u32 s62, s58, 1064960
buffer_load_dwordx4 v10, s[40:43], s62 offen lds
v_mfma_f32_16x16x32_bf16 v[92:95], v[124:127], v[100:103], v[92:95]
s_add_u32 m0, s5, 49152
s_add_u32 s62, s65, 1024
buffer_load_dwordx4 v8, s[24:27], s62 offen lds
s_waitcnt vmcnt(9)
s_barrier
s_waitcnt lgkmcnt(0)
v_mfma_f32_16x16x32_bf16 v[64:67], v[128:131], v[104:107], v[64:67]
ds_read_b128 v[96:99], v28 offset:0
ds_read_b128 v[100:103], v28 offset:2048
v_mfma_f32_16x16x32_bf16 v[80:83], v[128:131], v[108:111], v[80:83]
ds_read_b64_tr_b16 v[112:113], v16 offset:0
ds_read_b64_tr_b16 v[114:115], v16 offset:512
v_mfma_f32_16x16x32_bf16 v[68:71], v[132:135], v[104:107], v[68:71]
ds_read_b64_tr_b16 v[116:117], v19 offset:0
ds_read_b64_tr_b16 v[118:119], v19 offset:512
v_mfma_f32_16x16x32_bf16 v[84:87], v[132:135], v[108:111], v[84:87]
ds_read_b64_tr_b16 v[120:121], v22 offset:0
ds_read_b64_tr_b16 v[122:123], v22 offset:512
v_mfma_f32_16x16x32_bf16 v[72:75], v[136:139], v[104:107], v[72:75]
ds_read_b64_tr_b16 v[124:125], v25 offset:0
ds_read_b64_tr_b16 v[126:127], v25 offset:512
v_mfma_f32_16x16x32_bf16 v[88:91], v[136:139], v[108:111], v[88:91]
s_add_u32 m0, s5, 50176
s_add_u32 s62, s65, 17408
buffer_load_dwordx4 v11, s[24:27], s62 offen lds
v_mfma_f32_16x16x32_bf16 v[76:79], v[140:143], v[104:107], v[76:79]
s_add_u32 m0, s5, 51200
s_add_u32 s62, s65, 33792
buffer_load_dwordx4 v8, s[24:27], s62 offen lds
v_mfma_f32_16x16x32_bf16 v[92:95], v[140:143], v[108:111], v[92:95]
s_add_u32 m0, s5, 52224
s_add_u32 s62, s65, 50176
buffer_load_dwordx4 v11, s[24:27], s62 offen lds
s_waitcnt lgkmcnt(0)
v_mfma_f32_16x16x32_bf16 v[64:67], v[112:115], v[96:99], v[64:67]
ds_read_b128 v[104:107], v31 offset:0
ds_read_b128 v[108:111], v31 offset:2048
v_mfma_f32_16x16x32_bf16 v[80:83], v[112:115], v[100:103], v[80:83]
ds_read_b64_tr_b16 v[128:129], v16 offset:4096
ds_read_b64_tr_b16 v[130:131], v16 offset:4608
v_mfma_f32_16x16x32_bf16 v[68:71], v[116:119], v[96:99], v[68:71]
ds_read_b64_tr_b16 v[132:133], v19 offset:4096
ds_read_b64_tr_b16 v[134:135], v19 offset:4608
v_mfma_f32_16x16x32_bf16 v[84:87], v[116:119], v[100:103], v[84:87]
ds_read_b64_tr_b16 v[136:137], v22 offset:4096
ds_read_b64_tr_b16 v[138:139], v22 offset:4608
v_mfma_f32_16x16x32_bf16 v[72:75], v[120:123], v[96:99], v[72:75]
ds_read_b64_tr_b16 v[140:141], v25 offset:4096
ds_read_b64_tr_b16 v[142:143], v25 offset:4608
v_mfma_f32_16x16x32_bf16 v[88:91], v[120:123], v[100:103], v[88:91]
s_add_u32 m0, s4, 73728
s_add_u32 s62, s58, 1179648
buffer_load_dwordx4 v9, s[40:43], s62 offen lds
v_mfma_f32_16x16x32_bf16 v[76:79], v[124:127], v[96:99], v[76:79]
s_add_u32 m0, s4, 74752
s_add_u32 s62, s58, 1196032
buffer_load_dwordx4 v10, s[40:43], s62 offen lds
v_mfma_f32_16x16x32_bf16 v[92:95], v[124:127], v[100:103], v[92:95]
s_add_u32 m0, s5, 73728
s_add_u32 s62, s65, 1152
buffer_load_dwordx4 v8, s[24:27], s62 offen lds
s_waitcnt vmcnt(9)
s_barrier
s_waitcnt lgkmcnt(0)
v_mfma_f32_16x16x32_bf16 v[64:67], v[128:131], v[104:107], v[64:67]
ds_read_b128 v[96:99], v28 offset:24576
ds_read_b128 v[100:103], v28 offset:26624
v_mfma_f32_16x16x32_bf16 v[80:83], v[128:131], v[108:111], v[80:83]
ds_read_b64_tr_b16 v[112:113], v16 offset:24576
ds_read_b64_tr_b16 v[114:115], v16 offset:25088
v_mfma_f32_16x16x32_bf16 v[68:71], v[132:135], v[104:107], v[68:71]
ds_read_b64_tr_b16 v[116:117], v19 offset:24576
ds_read_b64_tr_b16 v[118:119], v19 offset:25088
v_mfma_f32_16x16x32_bf16 v[84:87], v[132:135], v[108:111], v[84:87]
ds_read_b64_tr_b16 v[120:121], v22 offset:24576
ds_read_b64_tr_b16 v[122:123], v22 offset:25088
v_mfma_f32_16x16x32_bf16 v[72:75], v[136:139], v[104:107], v[72:75]
ds_read_b64_tr_b16 v[124:125], v25 offset:24576
ds_read_b64_tr_b16 v[126:127], v25 offset:25088
v_mfma_f32_16x16x32_bf16 v[88:91], v[136:139], v[108:111], v[88:91]
s_add_u32 m0, s5, 74752
s_add_u32 s62, s65, 17536
buffer_load_dwordx4 v11, s[24:27], s62 offen lds
v_mfma_f32_16x16x32_bf16 v[76:79], v[140:143], v[104:107], v[76:79]
s_add_u32 m0, s5, 75776
s_add_u32 s62, s65, 33920
buffer_load_dwordx4 v8, s[24:27], s62 offen lds
v_mfma_f32_16x16x32_bf16 v[92:95], v[140:143], v[108:111], v[92:95]
s_add_u32 m0, s5, 76800
s_add_u32 s62, s65, 50304
buffer_load_dwordx4 v11, s[24:27], s62 offen lds
s_waitcnt lgkmcnt(0)
v_mfma_f32_16x16x32_bf16 v[64:67], v[112:115], v[96:99], v[64:67]
ds_read_b128 v[104:107], v31 offset:24576
ds_read_b128 v[108:111], v31 offset:26624
v_mfma_f32_16x16x32_bf16 v[80:83], v[112:115], v[100:103], v[80:83]
ds_read_b64_tr_b16 v[128:129], v16 offset:28672
ds_read_b64_tr_b16 v[130:131], v16 offset:29184
v_mfma_f32_16x16x32_bf16 v[68:71], v[116:119], v[96:99], v[68:71]
ds_read_b64_tr_b16 v[132:133], v19 offset:28672
ds_read_b64_tr_b16 v[134:135], v19 offset:29184
v_mfma_f32_16x16x32_bf16 v[84:87], v[116:119], v[100:103], v[84:87]
ds_read_b64_tr_b16 v[136:137], v22 offset:28672
ds_read_b64_tr_b16 v[138:139], v22 offset:29184
v_mfma_f32_16x16x32_bf16 v[72:75], v[120:123], v[96:99], v[72:75]
ds_read_b64_tr_b16 v[140:141], v25 offset:28672
ds_read_b64_tr_b16 v[142:143], v25 offset:29184
v_mfma_f32_16x16x32_bf16 v[88:91], v[120:123], v[100:103], v[88:91]
s_add_u32 m0, s4, 98304
s_add_u32 s62, s58, 1310720
buffer_load_dwordx4 v9, s[40:43], s62 offen lds
v_mfma_f32_16x16x32_bf16 v[76:79], v[124:127], v[96:99], v[76:79]
s_add_u32 m0, s4, 99328
s_add_u32 s62, s58, 1327104
buffer_load_dwordx4 v10, s[40:43], s62 offen lds
v_mfma_f32_16x16x32_bf16 v[92:95], v[124:127], v[100:103], v[92:95]
s_add_u32 m0, s5, 98304
s_add_u32 s62, s65, 1280
buffer_load_dwordx4 v8, s[24:27], s62 offen lds
s_waitcnt vmcnt(9)
s_barrier
s_waitcnt lgkmcnt(0)
v_mfma_f32_16x16x32_bf16 v[64:67], v[128:131], v[104:107], v[64:67]
ds_read_b128 v[96:99], v29 offset:0
ds_read_b128 v[100:103], v29 offset:2048
v_mfma_f32_16x16x32_bf16 v[80:83], v[128:131], v[108:111], v[80:83]
ds_read_b64_tr_b16 v[112:113], v17 offset:0
ds_read_b64_tr_b16 v[114:115], v17 offset:512
v_mfma_f32_16x16x32_bf16 v[68:71], v[132:135], v[104:107], v[68:71]
ds_read_b64_tr_b16 v[116:117], v20 offset:0
ds_read_b64_tr_b16 v[118:119], v20 offset:512
v_mfma_f32_16x16x32_bf16 v[84:87], v[132:135], v[108:111], v[84:87]
ds_read_b64_tr_b16 v[120:121], v23 offset:0
ds_read_b64_tr_b16 v[122:123], v23 offset:512
v_mfma_f32_16x16x32_bf16 v[72:75], v[136:139], v[104:107], v[72:75]
ds_read_b64_tr_b16 v[124:125], v26 offset:0
ds_read_b64_tr_b16 v[126:127], v26 offset:512
v_mfma_f32_16x16x32_bf16 v[88:91], v[136:139], v[108:111], v[88:91]
s_add_u32 m0, s5, 99328
s_add_u32 s62, s65, 17664
buffer_load_dwordx4 v11, s[24:27], s62 offen lds
v_mfma_f32_16x16x32_bf16 v[76:79], v[140:143], v[104:107], v[76:79]
s_add_u32 m0, s5, 100352
s_add_u32 s62, s65, 34048
buffer_load_dwordx4 v8, s[24:27], s62 offen lds
v_mfma_f32_16x16x32_bf16 v[92:95], v[140:143], v[108:111], v[92:95]
s_add_u32 m0, s5, 101376
s_add_u32 s62, s65, 50432
buffer_load_dwordx4 v11, s[24:27], s62 offen lds
s_waitcnt lgkmcnt(0)
v_mfma_f32_16x16x32_bf16 v[64:67], v[112:115], v[96:99], v[64:67]
ds_read_b128 v[104:107], v32 offset:0
ds_read_b128 v[108:111], v32 offset:2048
v_mfma_f32_16x16x32_bf16 v[80:83], v[112:115], v[100:103], v[80:83]
ds_read_b64_tr_b16 v[128:129], v17 offset:4096
ds_read_b64_tr_b16 v[130:131], v17 offset:4608
v_mfma_f32_16x16x32_bf16 v[68:71], v[116:119], v[96:99], v[68:71]
ds_read_b64_tr_b16 v[132:133], v20 offset:4096
ds_read_b64_tr_b16 v[134:135], v20 offset:4608
v_mfma_f32_16x16x32_bf16 v[84:87], v[116:119], v[100:103], v[84:87]
ds_read_b64_tr_b16 v[136:137], v23 offset:4096
ds_read_b64_tr_b16 v[138:139], v23 offset:4608
v_mfma_f32_16x16x32_bf16 v[72:75], v[120:123], v[96:99], v[72:75]
ds_read_b64_tr_b16 v[140:141], v26 offset:4096
ds_read_b64_tr_b16 v[142:143], v26 offset:4608
v_mfma_f32_16x16x32_bf16 v[88:91], v[120:123], v[100:103], v[88:91]
s_add_u32 m0, s4, 122880
s_add_u32 s62, s58, 1441792
buffer_load_dwordx4 v9, s[40:43], s62 offen lds
v_mfma_f32_16x16x32_bf16 v[76:79], v[124:127], v[96:99], v[76:79]
s_add_u32 m0, s4, 123904
s_add_u32 s62, s58, 1458176
buffer_load_dwordx4 v10, s[40:43], s62 offen lds
v_mfma_f32_16x16x32_bf16 v[92:95], v[124:127], v[100:103], v[92:95]
s_add_u32 m0, s5, 122880
s_add_u32 s62, s65, 1408
buffer_load_dwordx4 v8, s[24:27], s62 offen lds
s_waitcnt vmcnt(9)
s_barrier
s_waitcnt lgkmcnt(0)
v_mfma_f32_16x16x32_bf16 v[64:67], v[128:131], v[104:107], v[64:67]
ds_read_b128 v[96:99], v29 offset:24576
ds_read_b128 v[100:103], v29 offset:26624
v_mfma_f32_16x16x32_bf16 v[80:83], v[128:131], v[108:111], v[80:83]
ds_read_b64_tr_b16 v[112:113], v17 offset:24576
ds_read_b64_tr_b16 v[114:115], v17 offset:25088
v_mfma_f32_16x16x32_bf16 v[68:71], v[132:135], v[104:107], v[68:71]
ds_read_b64_tr_b16 v[116:117], v20 offset:24576
ds_read_b64_tr_b16 v[118:119], v20 offset:25088
v_mfma_f32_16x16x32_bf16 v[84:87], v[132:135], v[108:111], v[84:87]
ds_read_b64_tr_b16 v[120:121], v23 offset:24576
ds_read_b64_tr_b16 v[122:123], v23 offset:25088
v_mfma_f32_16x16x32_bf16 v[72:75], v[136:139], v[104:107], v[72:75]
ds_read_b64_tr_b16 v[124:125], v26 offset:24576
ds_read_b64_tr_b16 v[126:127], v26 offset:25088
v_mfma_f32_16x16x32_bf16 v[88:91], v[136:139], v[108:111], v[88:91]
s_add_u32 m0, s5, 123904
s_add_u32 s62, s65, 17792
buffer_load_dwordx4 v11, s[24:27], s62 offen lds
v_mfma_f32_16x16x32_bf16 v[76:79], v[140:143], v[104:107], v[76:79]
s_add_u32 m0, s5, 124928
s_add_u32 s62, s65, 34176
buffer_load_dwordx4 v8, s[24:27], s62 offen lds
v_mfma_f32_16x16x32_bf16 v[92:95], v[140:143], v[108:111], v[92:95]
s_add_u32 m0, s5, 125952
s_add_u32 s62, s65, 50560
buffer_load_dwordx4 v11, s[24:27], s62 offen lds
s_waitcnt lgkmcnt(0)
v_mfma_f32_16x16x32_bf16 v[64:67], v[112:115], v[96:99], v[64:67]
ds_read_b128 v[104:107], v32 offset:24576
ds_read_b128 v[108:111], v32 offset:26624
v_mfma_f32_16x16x32_bf16 v[80:83], v[112:115], v[100:103], v[80:83]
ds_read_b64_tr_b16 v[128:129], v17 offset:28672
ds_read_b64_tr_b16 v[130:131], v17 offset:29184
v_mfma_f32_16x16x32_bf16 v[68:71], v[116:119], v[96:99], v[68:71]
ds_read_b64_tr_b16 v[132:133], v20 offset:28672
ds_read_b64_tr_b16 v[134:135], v20 offset:29184
v_mfma_f32_16x16x32_bf16 v[84:87], v[116:119], v[100:103], v[84:87]
ds_read_b64_tr_b16 v[136:137], v23 offset:28672
ds_read_b64_tr_b16 v[138:139], v23 offset:29184
v_mfma_f32_16x16x32_bf16 v[72:75], v[120:123], v[96:99], v[72:75]
ds_read_b64_tr_b16 v[140:141], v26 offset:28672
ds_read_b64_tr_b16 v[142:143], v26 offset:29184
v_mfma_f32_16x16x32_bf16 v[88:91], v[120:123], v[100:103], v[88:91]
s_add_u32 m0, s4, 0
s_add_u32 s62, s58, 1572864
buffer_load_dwordx4 v9, s[40:43], s62 offen lds
v_mfma_f32_16x16x32_bf16 v[76:79], v[124:127], v[96:99], v[76:79]
s_add_u32 m0, s4, 1024
s_add_u32 s62, s58, 1589248
buffer_load_dwordx4 v10, s[40:43], s62 offen lds
v_mfma_f32_16x16x32_bf16 v[92:95], v[124:127], v[100:103], v[92:95]
s_add_u32 m0, s5, 0
s_add_u32 s62, s65, 1536
buffer_load_dwordx4 v8, s[24:27], s62 offen lds
s_waitcnt vmcnt(9)
s_barrier
s_waitcnt lgkmcnt(0)
v_mfma_f32_16x16x32_bf16 v[64:67], v[128:131], v[104:107], v[64:67]
ds_read_b128 v[96:99], v30 offset:0
ds_read_b128 v[100:103], v30 offset:2048
v_mfma_f32_16x16x32_bf16 v[80:83], v[128:131], v[108:111], v[80:83]
ds_read_b64_tr_b16 v[112:113], v18 offset:0
ds_read_b64_tr_b16 v[114:115], v18 offset:512
v_mfma_f32_16x16x32_bf16 v[68:71], v[132:135], v[104:107], v[68:71]
ds_read_b64_tr_b16 v[116:117], v21 offset:0
ds_read_b64_tr_b16 v[118:119], v21 offset:512
v_mfma_f32_16x16x32_bf16 v[84:87], v[132:135], v[108:111], v[84:87]
ds_read_b64_tr_b16 v[120:121], v24 offset:0
ds_read_b64_tr_b16 v[122:123], v24 offset:512
v_mfma_f32_16x16x32_bf16 v[72:75], v[136:139], v[104:107], v[72:75]
ds_read_b64_tr_b16 v[124:125], v27 offset:0
ds_read_b64_tr_b16 v[126:127], v27 offset:512
v_mfma_f32_16x16x32_bf16 v[88:91], v[136:139], v[108:111], v[88:91]
s_add_u32 m0, s5, 1024
s_add_u32 s62, s65, 17920
buffer_load_dwordx4 v11, s[24:27], s62 offen lds
v_mfma_f32_16x16x32_bf16 v[76:79], v[140:143], v[104:107], v[76:79]
s_add_u32 m0, s5, 2048
s_add_u32 s62, s65, 34304
buffer_load_dwordx4 v8, s[24:27], s62 offen lds
v_mfma_f32_16x16x32_bf16 v[92:95], v[140:143], v[108:111], v[92:95]
s_add_u32 m0, s5, 3072
s_add_u32 s62, s65, 50688
buffer_load_dwordx4 v11, s[24:27], s62 offen lds
s_waitcnt lgkmcnt(0)
v_mfma_f32_16x16x32_bf16 v[64:67], v[112:115], v[96:99], v[64:67]
ds_read_b128 v[104:107], v33 offset:0
ds_read_b128 v[108:111], v33 offset:2048
v_mfma_f32_16x16x32_bf16 v[80:83], v[112:115], v[100:103], v[80:83]
ds_read_b64_tr_b16 v[128:129], v18 offset:4096
ds_read_b64_tr_b16 v[130:131], v18 offset:4608
v_mfma_f32_16x16x32_bf16 v[68:71], v[116:119], v[96:99], v[68:71]
ds_read_b64_tr_b16 v[132:133], v21 offset:4096
ds_read_b64_tr_b16 v[134:135], v21 offset:4608
v_mfma_f32_16x16x32_bf16 v[84:87], v[116:119], v[100:103], v[84:87]
ds_read_b64_tr_b16 v[136:137], v24 offset:4096
ds_read_b64_tr_b16 v[138:139], v24 offset:4608
v_mfma_f32_16x16x32_bf16 v[72:75], v[120:123], v[96:99], v[72:75]
ds_read_b64_tr_b16 v[140:141], v27 offset:4096
ds_read_b64_tr_b16 v[142:143], v27 offset:4608
v_mfma_f32_16x16x32_bf16 v[88:91], v[120:123], v[100:103], v[88:91]
s_add_u32 m0, s4, 24576
s_add_u32 s62, s58, 1703936
buffer_load_dwordx4 v9, s[40:43], s62 offen lds
v_mfma_f32_16x16x32_bf16 v[76:79], v[124:127], v[96:99], v[76:79]
s_add_u32 m0, s4, 25600
s_add_u32 s62, s58, 1720320
buffer_load_dwordx4 v10, s[40:43], s62 offen lds
v_mfma_f32_16x16x32_bf16 v[92:95], v[124:127], v[100:103], v[92:95]
s_add_u32 m0, s5, 24576
s_add_u32 s62, s65, 1664
buffer_load_dwordx4 v8, s[24:27], s62 offen lds
s_waitcnt vmcnt(9)
s_barrier
s_waitcnt lgkmcnt(0)
v_mfma_f32_16x16x32_bf16 v[64:67], v[128:131], v[104:107], v[64:67]
ds_read_b128 v[96:99], v30 offset:24576
ds_read_b128 v[100:103], v30 offset:26624
v_mfma_f32_16x16x32_bf16 v[80:83], v[128:131], v[108:111], v[80:83]
ds_read_b64_tr_b16 v[112:113], v18 offset:24576
ds_read_b64_tr_b16 v[114:115], v18 offset:25088
v_mfma_f32_16x16x32_bf16 v[68:71], v[132:135], v[104:107], v[68:71]
ds_read_b64_tr_b16 v[116:117], v21 offset:24576
ds_read_b64_tr_b16 v[118:119], v21 offset:25088
v_mfma_f32_16x16x32_bf16 v[84:87], v[132:135], v[108:111], v[84:87]
ds_read_b64_tr_b16 v[120:121], v24 offset:24576
ds_read_b64_tr_b16 v[122:123], v24 offset:25088
v_mfma_f32_16x16x32_bf16 v[72:75], v[136:139], v[104:107], v[72:75]
ds_read_b64_tr_b16 v[124:125], v27 offset:24576
ds_read_b64_tr_b16 v[126:127], v27 offset:25088
v_mfma_f32_16x16x32_bf16 v[88:91], v[136:139], v[108:111], v[88:91]
s_add_u32 m0, s5, 25600
s_add_u32 s62, s65, 18048
buffer_load_dwordx4 v11, s[24:27], s62 offen lds
v_mfma_f32_16x16x32_bf16 v[76:79], v[140:143], v[104:107], v[76:79]
s_add_u32 m0, s5, 26624
s_add_u32 s62, s65, 34432
buffer_load_dwordx4 v8, s[24:27], s62 offen lds
v_mfma_f32_16x16x32_bf16 v[92:95], v[140:143], v[108:111], v[92:95]
s_add_u32 m0, s5, 27648
s_add_u32 s62, s65, 50816
buffer_load_dwordx4 v11, s[24:27], s62 offen lds
s_waitcnt lgkmcnt(0)
v_mfma_f32_16x16x32_bf16 v[64:67], v[112:115], v[96:99], v[64:67]
ds_read_b128 v[104:107], v33 offset:24576
ds_read_b128 v[108:111], v33 offset:26624
v_mfma_f32_16x16x32_bf16 v[80:83], v[112:115], v[100:103], v[80:83]
ds_read_b64_tr_b16 v[128:129], v18 offset:28672
ds_read_b64_tr_b16 v[130:131], v18 offset:29184
v_mfma_f32_16x16x32_bf16 v[68:71], v[116:119], v[96:99], v[68:71]
ds_read_b64_tr_b16 v[132:133], v21 offset:28672
ds_read_b64_tr_b16 v[134:135], v21 offset:29184
v_mfma_f32_16x16x32_bf16 v[84:87], v[116:119], v[100:103], v[84:87]
ds_read_b64_tr_b16 v[136:137], v24 offset:28672
ds_read_b64_tr_b16 v[138:139], v24 offset:29184
v_mfma_f32_16x16x32_bf16 v[72:75], v[120:123], v[96:99], v[72:75]
ds_read_b64_tr_b16 v[140:141], v27 offset:28672
ds_read_b64_tr_b16 v[142:143], v27 offset:29184
v_mfma_f32_16x16x32_bf16 v[88:91], v[120:123], v[100:103], v[88:91]
s_add_u32 m0, s4, 49152
s_add_u32 s62, s58, 1835008
buffer_load_dwordx4 v9, s[40:43], s62 offen lds
v_mfma_f32_16x16x32_bf16 v[76:79], v[124:127], v[96:99], v[76:79]
s_add_u32 m0, s4, 50176
s_add_u32 s62, s58, 1851392
buffer_load_dwordx4 v10, s[40:43], s62 offen lds
v_mfma_f32_16x16x32_bf16 v[92:95], v[124:127], v[100:103], v[92:95]
s_add_u32 m0, s5, 49152
s_add_u32 s62, s65, 1792
buffer_load_dwordx4 v8, s[24:27], s62 offen lds
s_waitcnt vmcnt(9)
s_barrier
s_waitcnt lgkmcnt(0)
v_mfma_f32_16x16x32_bf16 v[64:67], v[128:131], v[104:107], v[64:67]
ds_read_b128 v[96:99], v28 offset:0
ds_read_b128 v[100:103], v28 offset:2048
v_mfma_f32_16x16x32_bf16 v[80:83], v[128:131], v[108:111], v[80:83]
ds_read_b64_tr_b16 v[112:113], v16 offset:0
ds_read_b64_tr_b16 v[114:115], v16 offset:512
v_mfma_f32_16x16x32_bf16 v[68:71], v[132:135], v[104:107], v[68:71]
ds_read_b64_tr_b16 v[116:117], v19 offset:0
ds_read_b64_tr_b16 v[118:119], v19 offset:512
v_mfma_f32_16x16x32_bf16 v[84:87], v[132:135], v[108:111], v[84:87]
ds_read_b64_tr_b16 v[120:121], v22 offset:0
ds_read_b64_tr_b16 v[122:123], v22 offset:512
v_mfma_f32_16x16x32_bf16 v[72:75], v[136:139], v[104:107], v[72:75]
ds_read_b64_tr_b16 v[124:125], v25 offset:0
ds_read_b64_tr_b16 v[126:127], v25 offset:512
v_mfma_f32_16x16x32_bf16 v[88:91], v[136:139], v[108:111], v[88:91]
s_add_u32 m0, s5, 50176
s_add_u32 s62, s65, 18176
buffer_load_dwordx4 v11, s[24:27], s62 offen lds
v_mfma_f32_16x16x32_bf16 v[76:79], v[140:143], v[104:107], v[76:79]
s_add_u32 m0, s5, 51200
s_add_u32 s62, s65, 34560
buffer_load_dwordx4 v8, s[24:27], s62 offen lds
v_mfma_f32_16x16x32_bf16 v[92:95], v[140:143], v[108:111], v[92:95]
s_add_u32 m0, s5, 52224
s_add_u32 s62, s65, 50944
buffer_load_dwordx4 v11, s[24:27], s62 offen lds
s_waitcnt lgkmcnt(0)
v_mfma_f32_16x16x32_bf16 v[64:67], v[112:115], v[96:99], v[64:67]
ds_read_b128 v[104:107], v31 offset:0
ds_read_b128 v[108:111], v31 offset:2048
v_mfma_f32_16x16x32_bf16 v[80:83], v[112:115], v[100:103], v[80:83]
ds_read_b64_tr_b16 v[128:129], v16 offset:4096
ds_read_b64_tr_b16 v[130:131], v16 offset:4608
v_mfma_f32_16x16x32_bf16 v[68:71], v[116:119], v[96:99], v[68:71]
ds_read_b64_tr_b16 v[132:133], v19 offset:4096
ds_read_b64_tr_b16 v[134:135], v19 offset:4608
v_mfma_f32_16x16x32_bf16 v[84:87], v[116:119], v[100:103], v[84:87]
ds_read_b64_tr_b16 v[136:137], v22 offset:4096
ds_read_b64_tr_b16 v[138:139], v22 offset:4608
v_mfma_f32_16x16x32_bf16 v[72:75], v[120:123], v[96:99], v[72:75]
ds_read_b64_tr_b16 v[140:141], v25 offset:4096
ds_read_b64_tr_b16 v[142:143], v25 offset:4608
v_mfma_f32_16x16x32_bf16 v[88:91], v[120:123], v[100:103], v[88:91]
s_add_u32 m0, s4, 73728
s_add_u32 s62, s58, 1966080
buffer_load_dwordx4 v9, s[40:43], s62 offen lds
v_mfma_f32_16x16x32_bf16 v[76:79], v[124:127], v[96:99], v[76:79]
s_add_u32 m0, s4, 74752
s_add_u32 s62, s58, 1982464
buffer_load_dwordx4 v10, s[40:43], s62 offen lds
v_mfma_f32_16x16x32_bf16 v[92:95], v[124:127], v[100:103], v[92:95]
s_add_u32 m0, s5, 73728
s_add_u32 s62, s65, 1920
buffer_load_dwordx4 v8, s[24:27], s62 offen lds
s_waitcnt vmcnt(9)
s_barrier
s_waitcnt lgkmcnt(0)
v_mfma_f32_16x16x32_bf16 v[64:67], v[128:131], v[104:107], v[64:67]
ds_read_b128 v[96:99], v28 offset:24576
ds_read_b128 v[100:103], v28 offset:26624
v_mfma_f32_16x16x32_bf16 v[80:83], v[128:131], v[108:111], v[80:83]
ds_read_b64_tr_b16 v[112:113], v16 offset:24576
ds_read_b64_tr_b16 v[114:115], v16 offset:25088
v_mfma_f32_16x16x32_bf16 v[68:71], v[132:135], v[104:107], v[68:71]
ds_read_b64_tr_b16 v[116:117], v19 offset:24576
ds_read_b64_tr_b16 v[118:119], v19 offset:25088
v_mfma_f32_16x16x32_bf16 v[84:87], v[132:135], v[108:111], v[84:87]
ds_read_b64_tr_b16 v[120:121], v22 offset:24576
ds_read_b64_tr_b16 v[122:123], v22 offset:25088
v_mfma_f32_16x16x32_bf16 v[72:75], v[136:139], v[104:107], v[72:75]
ds_read_b64_tr_b16 v[124:125], v25 offset:24576
ds_read_b64_tr_b16 v[126:127], v25 offset:25088
v_mfma_f32_16x16x32_bf16 v[88:91], v[136:139], v[108:111], v[88:91]
s_add_u32 m0, s5, 74752
s_add_u32 s62, s65, 18304
buffer_load_dwordx4 v11, s[24:27], s62 offen lds
v_mfma_f32_16x16x32_bf16 v[76:79], v[140:143], v[104:107], v[76:79]
s_add_u32 m0, s5, 75776
s_add_u32 s62, s65, 34688
buffer_load_dwordx4 v8, s[24:27], s62 offen lds
v_mfma_f32_16x16x32_bf16 v[92:95], v[140:143], v[108:111], v[92:95]
s_add_u32 m0, s5, 76800
s_add_u32 s62, s65, 51072
buffer_load_dwordx4 v11, s[24:27], s62 offen lds
s_waitcnt lgkmcnt(0)
v_mfma_f32_16x16x32_bf16 v[64:67], v[112:115], v[96:99], v[64:67]
ds_read_b128 v[104:107], v31 offset:24576
ds_read_b128 v[108:111], v31 offset:26624
v_mfma_f32_16x16x32_bf16 v[80:83], v[112:115], v[100:103], v[80:83]
ds_read_b64_tr_b16 v[128:129], v16 offset:28672
ds_read_b64_tr_b16 v[130:131], v16 offset:29184
v_mfma_f32_16x16x32_bf16 v[68:71], v[116:119], v[96:99], v[68:71]
ds_read_b64_tr_b16 v[132:133], v19 offset:28672
ds_read_b64_tr_b16 v[134:135], v19 offset:29184
v_mfma_f32_16x16x32_bf16 v[84:87], v[116:119], v[100:103], v[84:87]
ds_read_b64_tr_b16 v[136:137], v22 offset:28672
ds_read_b64_tr_b16 v[138:139], v22 offset:29184
v_mfma_f32_16x16x32_bf16 v[72:75], v[120:123], v[96:99], v[72:75]
ds_read_b64_tr_b16 v[140:141], v25 offset:28672
ds_read_b64_tr_b16 v[142:143], v25 offset:29184
v_mfma_f32_16x16x32_bf16 v[88:91], v[120:123], v[100:103], v[88:91]
v_mfma_f32_16x16x32_bf16 v[76:79], v[124:127], v[96:99], v[76:79]
v_mfma_f32_16x16x32_bf16 v[92:95], v[124:127], v[100:103], v[92:95]
s_waitcnt vmcnt(6)
s_barrier
s_waitcnt lgkmcnt(0)
v_mfma_f32_16x16x32_bf16 v[64:67], v[128:131], v[104:107], v[64:67]
ds_read_b128 v[96:99], v29 offset:0
ds_read_b128 v[100:103], v29 offset:2048
v_mfma_f32_16x16x32_bf16 v[80:83], v[128:131], v[108:111], v[80:83]
ds_read_b64_tr_b16 v[112:113], v17 offset:0
ds_read_b64_tr_b16 v[114:115], v17 offset:512
v_mfma_f32_16x16x32_bf16 v[68:71], v[132:135], v[104:107], v[68:71]
ds_read_b64_tr_b16 v[116:117], v20 offset:0
ds_read_b64_tr_b16 v[118:119], v20 offset:512
v_mfma_f32_16x16x32_bf16 v[84:87], v[132:135], v[108:111], v[84:87]
ds_read_b64_tr_b16 v[120:121], v23 offset:0
ds_read_b64_tr_b16 v[122:123], v23 offset:512
v_mfma_f32_16x16x32_bf16 v[72:75], v[136:139], v[104:107], v[72:75]
ds_read_b64_tr_b16 v[124:125], v26 offset:0
ds_read_b64_tr_b16 v[126:127], v26 offset:512
v_mfma_f32_16x16x32_bf16 v[88:91], v[136:139], v[108:111], v[88:91]
v_mfma_f32_16x16x32_bf16 v[76:79], v[140:143], v[104:107], v[76:79]
v_mfma_f32_16x16x32_bf16 v[92:95], v[140:143], v[108:111], v[92:95]
s_waitcnt lgkmcnt(0)
v_mfma_f32_16x16x32_bf16 v[64:67], v[112:115], v[96:99], v[64:67]
ds_read_b128 v[104:107], v32 offset:0
ds_read_b128 v[108:111], v32 offset:2048
v_mfma_f32_16x16x32_bf16 v[80:83], v[112:115], v[100:103], v[80:83]
ds_read_b64_tr_b16 v[128:129], v17 offset:4096
ds_read_b64_tr_b16 v[130:131], v17 offset:4608
v_mfma_f32_16x16x32_bf16 v[68:71], v[116:119], v[96:99], v[68:71]
ds_read_b64_tr_b16 v[132:133], v20 offset:4096
ds_read_b64_tr_b16 v[134:135], v20 offset:4608
v_mfma_f32_16x16x32_bf16 v[84:87], v[116:119], v[100:103], v[84:87]
ds_read_b64_tr_b16 v[136:137], v23 offset:4096
ds_read_b64_tr_b16 v[138:139], v23 offset:4608
v_mfma_f32_16x16x32_bf16 v[72:75], v[120:123], v[96:99], v[72:75]
ds_read_b64_tr_b16 v[140:141], v26 offset:4096
ds_read_b64_tr_b16 v[142:143], v26 offset:4608
v_mfma_f32_16x16x32_bf16 v[88:91], v[120:123], v[100:103], v[88:91]
v_mfma_f32_16x16x32_bf16 v[76:79], v[124:127], v[96:99], v[76:79]
v_mfma_f32_16x16x32_bf16 v[92:95], v[124:127], v[100:103], v[92:95]
s_waitcnt vmcnt(0)
s_barrier
s_waitcnt lgkmcnt(0)
v_mfma_f32_16x16x32_bf16 v[64:67], v[128:131], v[104:107], v[64:67]
ds_read_b128 v[96:99], v29 offset:24576
ds_read_b128 v[100:103], v29 offset:26624
v_mfma_f32_16x16x32_bf16 v[80:83], v[128:131], v[108:111], v[80:83]
ds_read_b64_tr_b16 v[112:113], v17 offset:24576
ds_read_b64_tr_b16 v[114:115], v17 offset:25088
v_mfma_f32_16x16x32_bf16 v[68:71], v[132:135], v[104:107], v[68:71]
ds_read_b64_tr_b16 v[116:117], v20 offset:24576
ds_read_b64_tr_b16 v[118:119], v20 offset:25088
v_mfma_f32_16x16x32_bf16 v[84:87], v[132:135], v[108:111], v[84:87]
ds_read_b64_tr_b16 v[120:121], v23 offset:24576
ds_read_b64_tr_b16 v[122:123], v23 offset:25088
v_mfma_f32_16x16x32_bf16 v[72:75], v[136:139], v[104:107], v[72:75]
ds_read_b64_tr_b16 v[124:125], v26 offset:24576
ds_read_b64_tr_b16 v[126:127], v26 offset:25088
v_mfma_f32_16x16x32_bf16 v[88:91], v[136:139], v[108:111], v[88:91]
v_mfma_f32_16x16x32_bf16 v[76:79], v[140:143], v[104:107], v[76:79]
v_mfma_f32_16x16x32_bf16 v[92:95], v[140:143], v[108:111], v[92:95]
s_waitcnt lgkmcnt(0)
v_mfma_f32_16x16x32_bf16 v[64:67], v[112:115], v[96:99], v[64:67]
ds_read_b128 v[104:107], v32 offset:24576
ds_read_b128 v[108:111], v32 offset:26624
v_mfma_f32_16x16x32_bf16 v[80:83], v[112:115], v[100:103], v[80:83]
ds_read_b64_tr_b16 v[128:129], v17 offset:28672
ds_read_b64_tr_b16 v[130:131], v17 offset:29184
v_mfma_f32_16x16x32_bf16 v[68:71], v[116:119], v[96:99], v[68:71]
ds_read_b64_tr_b16 v[132:133], v20 offset:28672
ds_read_b64_tr_b16 v[134:135], v20 offset:29184
v_mfma_f32_16x16x32_bf16 v[84:87], v[116:119], v[100:103], v[84:87]
ds_read_b64_tr_b16 v[136:137], v23 offset:28672
ds_read_b64_tr_b16 v[138:139], v23 offset:29184
v_mfma_f32_16x16x32_bf16 v[72:75], v[120:123], v[96:99], v[72:75]
ds_read_b64_tr_b16 v[140:141], v26 offset:28672
ds_read_b64_tr_b16 v[142:143], v26 offset:29184
v_mfma_f32_16x16x32_bf16 v[88:91], v[120:123], v[100:103], v[88:91]
v_mfma_f32_16x16x32_bf16 v[76:79], v[124:127], v[96:99], v[76:79]
v_mfma_f32_16x16x32_bf16 v[92:95], v[124:127], v[100:103], v[92:95]
s_waitcnt lgkmcnt(0)
v_mfma_f32_16x16x32_bf16 v[64:67], v[128:131], v[104:107], v[64:67]
v_mfma_f32_16x16x32_bf16 v[80:83], v[128:131], v[108:111], v[80:83]
v_mfma_f32_16x16x32_bf16 v[68:71], v[132:135], v[104:107], v[68:71]
v_mfma_f32_16x16x32_bf16 v[84:87], v[132:135], v[108:111], v[84:87]
v_mfma_f32_16x16x32_bf16 v[72:75], v[136:139], v[104:107], v[72:75]
v_mfma_f32_16x16x32_bf16 v[88:91], v[136:139], v[108:111], v[88:91]
v_mfma_f32_16x16x32_bf16 v[76:79], v[140:143], v[104:107], v[76:79]
v_mfma_f32_16x16x32_bf16 v[92:95], v[140:143], v[108:111], v[92:95]
s_lshl_b32 s61, s64, 1
s_lshr_b32 s62, s3, 1
s_add_u32 s61, s61, s62
s_lshl_b32 s61, s61, 5
s_lshl_b32 s62, s59, 1
s_add_u32 s61, s61, s62
s_lshl_b32 s61, s61, 2
s_and_b32 s62, s3, 1
s_lshl_b32 s62, s62, 1
s_add_u32 s61, s61, s62
s_lshl_b32 s61, s61, 10
s_add_u32 s62, s61, 4096
v_cvt_pk_bf16_f32 v96, v64, v65
v_cvt_pk_bf16_f32 v97, v66, v67
v_cvt_pk_bf16_f32 v98, v68, v69
v_cvt_pk_bf16_f32 v99, v70, v71
v_cvt_pk_bf16_f32 v100, v72, v73
v_cvt_pk_bf16_f32 v101, v74, v75
v_cvt_pk_bf16_f32 v102, v76, v77
v_cvt_pk_bf16_f32 v103, v78, v79
v_cvt_pk_bf16_f32 v104, v80, v81
v_cvt_pk_bf16_f32 v105, v82, v83
v_cvt_pk_bf16_f32 v106, v84, v85
v_cvt_pk_bf16_f32 v107, v86, v87
v_cvt_pk_bf16_f32 v108, v88, v89
v_cvt_pk_bf16_f32 v109, v90, v91
v_cvt_pk_bf16_f32 v110, v92, v93
v_cvt_pk_bf16_f32 v111, v94, v95
buffer_store_dwordx4 v[96:99], v2, s[52:55], s61 offen offset:0 sc1
buffer_store_dwordx4 v[100:103], v2, s[52:55], s62 offen offset:0 sc1
buffer_store_dwordx4 v[104:107], v2, s[52:55], s61 offen offset:1024 sc1
buffer_store_dwordx4 v[108:111], v2, s[52:55], s62 offen offset:1024 sc1
s_lshl_b32 s61, s64, 4
s_add_u32 s61, s61, s59
s_lshl_b32 s61, s61, 5
s_add_u32 s61, s61, 3211264
v_mov_b32 v8, 0
v_mov_b32 v7, s60
s_waitcnt vmcnt(0)
s_barrier
s_cmp_lg_u32 s3, 0
s_cbranch_scc1 L_f1done
v_lshlrev_b32 v8, 12, v1
s_mov_b64 exec, 0xff
buffer_store_dword v7, v8, s[52:55], s61 offen sc1
s_mov_b64 exec, -1
L_f1done:
v_cmp_lt_u32 vcc, 27, v1
s_nop 1
v_cndmask_b32 v8, 0, 1, vcc
v_mul_u32_u24 v9, 28, v8
v_sub_u32 v9, v1, v9
v_lshlrev_b32 v9, 7, v9
v_mul_u32_u24 v8, 7168, v8
v_add_u32 v8, v8, v9
s_sub_u32 s61, s57, 28
s_lshl_b32 s61, s61, 2
s_add_u32 s61, s61, s3
s_lshl_b32 s61, s61, 1
s_lshr_b32 s62, s56, 1
s_mul_i32 s62, s62, 896
s_add_u32 s61, s61, s62
s_add_u32 s61, s61, 448
s_mul_i32 s61, s61, 7168
s_mul_i32 s62, s64, 3584
s_add_u32 s61, s61, s62
s_mov_b32 exec_hi, 0xffffff
buffer_load_dword v10, v8, s[44:47], s61 offen
s_add_u32 s61, s61, 229376
s_waitcnt vmcnt(1)
buffer_load_dword v11, v8, s[44:47], s61 offen
s_add_u32 s61, s61, 229376
s_waitcnt vmcnt(1)
buffer_load_dword v10, v8, s[44:47], s61 offen
s_add_u32 s61, s61, 229376
s_waitcnt vmcnt(1)
buffer_load_dword v11, v8, s[44:47], s61 offen
s_add_u32 s61, s61, 229376
s_waitcnt vmcnt(1)
buffer_load_dword v10, v8, s[44:47], s61 offen
s_add_u32 s61, s61, 229376
s_waitcnt vmcnt(1)
buffer_load_dword v11, v8, s[44:47], s61 offen
s_add_u32 s61, s61, 229376
s_waitcnt vmcnt(1)
buffer_load_dword v10, v8, s[44:47], s61 offen
s_add_u32 s61, s61, 229376
s_waitcnt vmcnt(1)
buffer_load_dword v11, v8, s[44:47], s61 offen
s_add_u32 s61, s61, 802816
s_waitcnt vmcnt(1)
buffer_load_dword v10, v8, s[44:47], s61 offen
s_sub_u32 s61, s61, 573440
s_waitcnt vmcnt(1)
buffer_load_dword v11, v8, s[44:47], s61 offen
s_add_u32 s61, s61, 802816
s_waitcnt vmcnt(1)
buffer_load_dword v10, v8, s[44:47], s61 offen
s_sub_u32 s61, s61, 573440
s_waitcnt vmcnt(1)
buffer_load_dword v11, v8, s[44:47], s61 offen
s_add_u32 s61, s61, 802816
s_waitcnt vmcnt(1)
buffer_load_dword v10, v8, s[44:47], s61 offen
s_add_u32 s61, s61, 229376
s_waitcnt vmcnt(1)
s_mov_b64 exec, -1
L_fin:
L_end:
s_endpgm
L_codeend:
.section .rodata,"a"
.p2align 6
.amdhsa_kernel standalone__weight_only_int_quip__sampling_kernel
  .amdhsa_next_free_vgpr 512
  .amdhsa_next_free_sgpr 102
  .amdhsa_accum_offset 256
  .amdhsa_group_segment_fixed_size 0
  .amdhsa_kernarg_size 72
  .amdhsa_user_sgpr_count 2
  .amdhsa_user_sgpr_kernarg_segment_ptr 1
  .amdhsa_system_sgpr_workgroup_id_x 1
.end_amdhsa_kernel
```
